```python
import torch

def _softmax(x, axis=-1):
    return torch.softmax(x, dim=axis)
def _gelu(x):
    return torch.nn.functional.gelu(x, approximate="tanh")
def _silu(x):
    return torch.nn.functional.silu(x)
def _sigmoid(x):
    return torch.sigmoid(x)
def _layernorm(x, axis=-1, eps=1e-5):
    m = x.mean(dim=axis, keepdim=True)
    v = x.var(dim=axis, keepdim=True, unbiased=False)
    return (x - m) / torch.sqrt(v + eps)
def _scatter_add(tgt, idx, src, axis=0):
    return tgt.clone().index_add_(axis, idx, src)
def _segment_sum(src, seg, n):
    out = torch.zeros((n,) + src.shape[1:], dtype=src.dtype)
    return out.index_add_(0, seg, src)
def _pad(x, pw):
    flat = tuple(v for pair in reversed(pw) for v in pair)
    return torch.nn.functional.pad(x, flat)

kernel_name = 'standalone__sliding_block__prompt'

def setup_inputs():

    _w = (lambda a: (lambda t: t.to(torch.bfloat16) if t.is_floating_point() else t)(torch.as_tensor(a)))
    B, S, D = 1, 2048, 640
    return {
        "x": _w((lambda *s: torch.randn(*s, dtype=torch.bfloat16) * 0.2)(B, S, D)),
        "wqkv": _w((lambda *s: torch.randn(*s, dtype=torch.bfloat16) * 0.2)(D, 3 * D)),
        "wo": _w((lambda *s: torch.randn(*s, dtype=torch.bfloat16) * 0.05)(D, D)),
    }

def reference(x, wqkv, wo):
    B, S, D = x.shape
    H = 32; Dh = D // H; W = 256
    qkv = (lambda x, *d: x.permute(*d))((x @ wqkv).reshape(B, S, 3, H, Dh), 2, 0, 3, 1, 4)
    q, k, v = qkv[0], qkv[1], qkv[2]
    scores = torch.einsum("bhqd,bhkd->bhqk", q, k) * (Dh ** -0.5)
    idx = torch.arange(S)
    mask = (idx[:, None] - idx[None, :] >= 0) & (idx[:, None] - idx[None, :] < W)
    scores = torch.where(mask[None, None], scores, -1e9)
    p = _softmax(scores, axis=-1)
    o = torch.einsum("bhqk,bhkd->bhqd", p, v)
    return (lambda x, *d: x.permute(*d))(o, 0, 2, 1, 3).reshape(B, S, D) @ wo
```

```asm
; @launch grid=(256,1,1) block=(512,1,1) lds=163840
.amdgcn_target "amdgcn-amd-amdhsa--gfx950"
.text
.globl standalone__sliding_block__prompt_kernel
.p2align 8
.type standalone__sliding_block__prompt_kernel,@function
standalone__sliding_block__prompt_kernel:
L_start:
    s_load_dwordx8 s[4:11], s[0:1], 0
    s_load_dwordx4 s[12:15], s[0:1], 32
    v_lshrrev_b32 v2, 6, v0
    v_and_b32 v1, 63, v0
    s_cmp_ge_u32 s2, 256
    s_cbranch_scc1 L_end
    v_readfirstlane_b32 s60, v2
    s_and_b32 s24, s2, 7
    s_lshr_b32 s25, s2, 3
    s_lshr_b32 s26, s24, 2
    s_mul_i32 s27, s26, 32
    s_add_u32 s27, s27, s25
    s_cmp_ge_u32 s25, 32
    s_cselect_b32 s3, 60, s27
    s_lshr_b32 s29, s27, 2
    s_and_b32 s30, s27, 3
    s_and_b32 s28, s24, 3
    s_lshl_b32 s28, s28, 2
    s_add_u32 s28, s28, s30
    s_and_b32 s61, s60, 3
    s_cmp_lt_u32 s60, 4
    s_cbranch_scc1 L_compute
    s_mul_i32 s31, s26, 8
    s_sub_u32 s31, s29, s31
    s_lshr_b32 s31, s31, 1
    s_mul_i32 s31, s31, 5
    s_lshr_b32 s30, s30, 1
    s_mul_i32 s30, s30, 10
    s_add_u32 s31, s31, s30
    s_lshr_b32 s32, s31, 1
    s_and_b32 s31, s24, 3
    s_mul_i32 s31, s31, 1
    s_add_u32 s32, s32, s31
    s_mul_i32 s31, s26, 1
    s_add_u32 s32, s32, s31
    s_mul_i32 s31, s32, 26
    s_lshr_b32 s31, s31, 8
    s_mul_i32 s31, s31, 10
    s_sub_u32 s32, s32, s31
    v_lshrrev_b32 v3, 3, v1
    v_mul_u32_u24 v3, 1280, v3
    v_and_b32 v14, 7, v1
    v_lshrrev_b32 v15, 4, v1
    v_xor_b32 v16, v14, v15
    s_and_b32 s31, s61, 1
    s_lshl_b32 s31, s31, 2
    v_xor_b32 v16, s31, v16
    v_lshl_add_u32 v4, v16, 4, v3
    v_xor_b32 v16, 4, v16
    v_lshl_add_u32 v5, v16, 4, v3
    v_add_u32 v5, 9216, v5
    v_add_u32 v6, 18432, v4
    v_mul_u32_u24 v3, 3840, v15
    v_and_b32 v14, 15, v1
    v_lshlrev_b32 v16, 2, v15
    v_xor_b32 v16, v14, v16
    v_lshl_add_u32 v8, v16, 4, v3
    v_add_u32 v9, 14336, v8
    v_add_u32 v10, 28672, v8
    v_add_u32 v11, 43008, v8
    s_mul_i32 s33, s28, 163840
    s_mul_i32 s31, s61, 30720
    s_add_u32 s33, s33, s31
    s_lshl_b32 s34, s29, 8
    s_mul_i32 s31, s61, 61440
    s_add_u32 s34, s34, s31
    s_mul_i32 s35, s61, 3072
    s_lshl_b32 s59, s61, 10
    s_add_u32 s59, s59, 12288
    s_mov_b32 s18, 2621440
    s_mov_b32 s19, 0x00020000
    s_mov_b32 s22, 2457600
    s_mov_b32 s23, 0x00020000
    s_mov_b32 s63, 1
    s_cmp_ge_u32 s3, 60
    s_waitcnt lgkmcnt(0)
    s_add_u32 s14, s14, 67108864
    s_addc_u32 s15, s15, 0
    s_cmp_ge_u32 s3, 60
    s_mov_b64 s[16:17], s[4:5]
    s_mov_b64 s[20:21], s[6:7]
    s_cbranch_scc1 H_nop1
    s_lshl_b32 s26, s32, 7
    s_add_u32 s26, s26, s33
    s_mov_b32 m0, s35
    s_mul_i32 s27, s32, 245760
    buffer_load_dwordx4 v4, s[16:19], s26 offen offset:0  lds
    buffer_load_dwordx4 v5, s[16:19], s26 offen offset:1024  lds
    buffer_load_dwordx4 v6, s[16:19], s26 offen offset:2048  lds
    s_add_u32 m0, s35, s59
    s_add_u32 s27, s27, s34
    buffer_load_dwordx4 v8, s[20:23], s27 offen offset:0  lds
    buffer_load_dwordx4 v9, s[20:23], s27 offen offset:1024  lds
    buffer_load_dwordx4 v10, s[20:23], s27 offen offset:2048  lds
    buffer_load_dwordx4 v11, s[20:23], s27 offen offset:3072  lds
    s_add_u32 s32, s32, 1
    s_cmp_eq_u32 s32, 10
    s_cselect_b32 s32, 0, s32
    s_add_u32 s35, s35, 28672
    s_sub_u32 s31, s35, 86016
    s_cmp_ge_u32 s35, 86016
    s_cselect_b32 s35, s31, s35
    s_lshl_b32 s26, s32, 7
    s_add_u32 s26, s26, s33
    s_mov_b32 m0, s35
    s_mul_i32 s27, s32, 245760
    buffer_load_dwordx4 v4, s[16:19], s26 offen offset:0  lds
    buffer_load_dwordx4 v5, s[16:19], s26 offen offset:1024  lds
    buffer_load_dwordx4 v6, s[16:19], s26 offen offset:2048  lds
    s_add_u32 m0, s35, s59
    s_add_u32 s27, s27, s34
    buffer_load_dwordx4 v8, s[20:23], s27 offen offset:0  lds
    buffer_load_dwordx4 v9, s[20:23], s27 offen offset:1024  lds
    buffer_load_dwordx4 v10, s[20:23], s27 offen offset:2048  lds
    buffer_load_dwordx4 v11, s[20:23], s27 offen offset:3072  lds
    s_add_u32 s32, s32, 1
    s_cmp_eq_u32 s32, 10
    s_cselect_b32 s32, 0, s32
    s_add_u32 s35, s35, 28672
    s_sub_u32 s31, s35, 86016
    s_cmp_ge_u32 s35, 86016
    s_cselect_b32 s35, s31, s35
    s_mov_b32 s36, s14
    s_mov_b32 s37, s15
    s_mov_b32 s38, 19271680
    s_mov_b32 s39, 0x00020000
    s_mov_b32 s48, s12
    s_mov_b32 s49, s13
    s_mov_b32 s50, 256
    s_mov_b32 s51, 0x00020000
    s_mov_b32 s40, s8
    s_mov_b32 s41, s9
    s_mov_b32 s42, 819200
    s_mov_b32 s43, 0x00020000
    s_mov_b32 s44, s10
    s_mov_b32 s45, s11
    s_mov_b32 s46, 2621440
    s_mov_b32 s47, 0x00020000
    s_mov_b32 s30, 8
H_loop:
    s_waitcnt vmcnt(7)
    s_barrier
    s_lshl_b32 s26, s32, 7
    s_add_u32 s26, s26, s33
    s_mov_b32 m0, s35
    s_mul_i32 s27, s32, 245760
    buffer_load_dwordx4 v4, s[16:19], s26 offen offset:0  lds
    buffer_load_dwordx4 v5, s[16:19], s26 offen offset:1024  lds
    buffer_load_dwordx4 v6, s[16:19], s26 offen offset:2048  lds
    s_add_u32 m0, s35, s59
    s_add_u32 s27, s27, s34
    buffer_load_dwordx4 v8, s[20:23], s27 offen offset:0  lds
    buffer_load_dwordx4 v9, s[20:23], s27 offen offset:1024  lds
    buffer_load_dwordx4 v10, s[20:23], s27 offen offset:2048  lds
    buffer_load_dwordx4 v11, s[20:23], s27 offen offset:3072  lds
    s_add_u32 s32, s32, 1
    s_cmp_eq_u32 s32, 10
    s_cselect_b32 s32, 0, s32
    s_add_u32 s35, s35, 28672
    s_sub_u32 s31, s35, 86016
    s_cmp_ge_u32 s35, 86016
    s_cselect_b32 s35, s31, s35
    s_sub_u32 s30, s30, 1
    s_cmp_lg_u32 s30, 0
    s_cbranch_scc1 H_loop
    s_mul_i32 s31, s61, 20480
    s_sub_u32 s33, s33, s31
    s_add_u32 s33, s33, 122880
    s_lshl_b32 s35, s61, 10
    s_waitcnt vmcnt(7)
    s_barrier
    s_add_u32 m0, s35, 86016
    s_lshl_b32 s26, s32, 7
    s_add_u32 s26, s26, s33
    buffer_load_dwordx4 v4, s[16:19], s26 offen lds
    s_add_u32 s32, s32, 1
    s_cmp_eq_u32 s32, 10
    s_cselect_b32 s32, 0, s32
    s_add_u32 m0, s35, 90112
    s_lshl_b32 s26, s32, 7
    s_add_u32 s26, s26, s33
    buffer_load_dwordx4 v4, s[16:19], s26 offen lds
    s_add_u32 s32, s32, 1
    s_cmp_eq_u32 s32, 10
    s_cselect_b32 s32, 0, s32
    s_add_u32 m0, s35, 94208
    s_lshl_b32 s26, s32, 7
    s_add_u32 s26, s26, s33
    buffer_load_dwordx4 v4, s[16:19], s26 offen lds
    s_add_u32 s32, s32, 1
    s_cmp_eq_u32 s32, 10
    s_cselect_b32 s32, 0, s32
    s_add_u32 m0, s35, 98304
    s_lshl_b32 s26, s32, 7
    s_add_u32 s26, s26, s33
    buffer_load_dwordx4 v4, s[16:19], s26 offen lds
    s_add_u32 s32, s32, 1
    s_cmp_eq_u32 s32, 10
    s_cselect_b32 s32, 0, s32
    s_add_u32 m0, s35, 103424
    s_lshl_b32 s26, s32, 7
    s_add_u32 s26, s26, s33
    buffer_load_dwordx4 v4, s[16:19], s26 offen lds
    s_add_u32 s32, s32, 1
    s_cmp_eq_u32 s32, 10
    s_cselect_b32 s32, 0, s32
    s_waitcnt vmcnt(5)
    s_barrier
    s_add_u32 m0, s35, 107520
    s_lshl_b32 s26, s32, 7
    s_add_u32 s26, s26, s33
    buffer_load_dwordx4 v4, s[16:19], s26 offen lds
    s_add_u32 s32, s32, 1
    s_cmp_eq_u32 s32, 10
    s_cselect_b32 s32, 0, s32
    s_add_u32 m0, s35, 111616
    s_lshl_b32 s26, s32, 7
    s_add_u32 s26, s26, s33
    buffer_load_dwordx4 v4, s[16:19], s26 offen lds
    s_add_u32 s32, s32, 1
    s_cmp_eq_u32 s32, 10
    s_cselect_b32 s32, 0, s32
    s_add_u32 m0, s35, 115712
    s_lshl_b32 s26, s32, 7
    s_add_u32 s26, s26, s33
    buffer_load_dwordx4 v4, s[16:19], s26 offen lds
    s_add_u32 s32, s32, 1
    s_cmp_eq_u32 s32, 10
    s_cselect_b32 s32, 0, s32
    s_add_u32 m0, s35, 119808
    s_lshl_b32 s26, s32, 7
    s_add_u32 s26, s26, s33
    buffer_load_dwordx4 v4, s[16:19], s26 offen lds
    s_add_u32 s32, s32, 1
    s_cmp_eq_u32 s32, 10
    s_cselect_b32 s32, 0, s32
    s_add_u32 m0, s35, 123904
    s_lshl_b32 s26, s32, 7
    s_add_u32 s26, s26, s33
    buffer_load_dwordx4 v4, s[16:19], s26 offen lds
    s_add_u32 s32, s32, 1
    s_cmp_eq_u32 s32, 10
    s_cselect_b32 s32, 0, s32
    v_mov_b32 v13, 0
    buffer_load_dword v12, v13, s[48:51], 0 offen sc1
    s_waitcnt vmcnt(6)
    s_barrier
    s_waitcnt vmcnt(0)
    s_barrier
    v_mov_b32 v31, 102400
    s_and_b32 s72, s25, 1
    s_lshl_b32 s73, s24, 1
    s_add_u32 s72, s72, s73
    s_lshr_b32 s75, s25, 1
    s_and_b32 s76, s61, 1
    s_lshl_b32 s71, s72, 1
    s_add_u32 s71, s71, s76
    s_lshr_b32 s77, s61, 1
    s_xor_b32 s78, s63, 1
    s_lshl_b32 s78, s78, 1
    s_lshl_b32 s70, s75, 2
    s_add_u32 s70, s70, s77
    s_lshl_b32 s73, s75, 4
    s_add_u32 s73, s73, s72
    s_lshl_b32 s73, s73, 7
    s_add_u32 s73, s73, 10485760
    s_add_u32 s66, s14, s73
    s_addc_u32 s67, s15, 0
    s_lshl_b32 s73, s24, 3
    s_and_b32 s74, s25, 2
    s_lshl_b32 s74, s74, 1
    s_add_u32 s73, s73, s74
    s_and_b32 s74, s25, 1
    s_add_u32 s73, s73, s74
    s_add_u32 s59, s73, s78
    s_lshl_b32 s73, s59, 3
    s_lshr_b32 s74, s25, 2
    s_add_u32 s73, s73, s74
    s_lshl_b32 s73, s73, 7
    s_lshr_b32 s74, s61, 1
    s_lshl_b32 s74, s74, 6
    s_add_u32 s73, s73, s74
    s_add_u32 s73, s73, 10551296
    s_add_u32 s68, s14, s73
    s_addc_u32 s69, s15, 0
    s_mul_i32 s79, s72, 163840
    s_mul_i32 s3, s70, 2560
    s_add_u32 s3, s3, s79
    s_and_b32 s72, s61, 1
    s_mul_i32 s73, s72, 2621440
    s_add_u32 s73, s73, s79
    s_add_u32 s73, s73, 2621440
    s_add_u32 s52, s14, s73
    s_addc_u32 s53, s15, 0
    s_mov_b32 s54, 163840
    s_mov_b32 s55, 0x00020000
    s_lshl_b32 s73, s75, 2
    s_sub_u32 s73, s73, 8
    s_mul_i32 s73, s73, 2560
    s_lshr_b32 s74, s61, 1
    s_mul_i32 s57, s74, 409600
    s_lshl_b32 s74, s74, 10
    s_add_u32 s73, s73, s74
    v_lshlrev_b32 v14, 4, v1
    v_add_u32 v29, s73, v14
    s_lshr_b32 s73, s25, 2
    s_mul_i32 s73, s73, 160
    s_add_u32 s57, s57, s73
    s_mul_i32 s58, s61, 25600
    s_mov_b32 s56, 0
    v_add_u32 v14, 0, v1
    v_mul_u32_u24 v15, 6554, v14
    v_lshrrev_b32 v15, 16, v15
    v_mul_u32_u24 v16, 10, v15
    v_sub_u32 v16, v14, v16
    v_and_b32 v17, 3, v15
    v_bfe_u32 v18, v15, 3, 1
    v_bfe_u32 v19, v15, 2, 1
    v_lshrrev_b32 v20, 4, v15
    v_lshl_add_u32 v21, v18, 2, v17
    v_lshl_add_u32 v21, v19, 3, v21
    v_mul_u32_u24 v22, 20, v20
    v_add_u32 v21, v21, v22
    v_mul_u32_u24 v21, 1280, v21
    v_lshl_add_u32 v144, v16, 4, v21
    v_lshl_add_u32 v21, v19, 1, v18
    v_lshl_add_u32 v21, v20, 2, v21
    v_mul_u32_u24 v21, 20, v21
    v_add3_u32 v21, v21, v17, 16
    v_mul_u32_u24 v21, 1280, v21
    v_lshl_add_u32 v149, v16, 4, v21
    v_add_u32 v14, 64, v1
    v_mul_u32_u24 v15, 6554, v14
    v_lshrrev_b32 v15, 16, v15
    v_mul_u32_u24 v16, 10, v15
    v_sub_u32 v16, v14, v16
    v_and_b32 v17, 3, v15
    v_bfe_u32 v18, v15, 3, 1
    v_bfe_u32 v19, v15, 2, 1
    v_lshrrev_b32 v20, 4, v15
    v_lshl_add_u32 v21, v18, 2, v17
    v_lshl_add_u32 v21, v19, 3, v21
    v_mul_u32_u24 v22, 20, v20
    v_add_u32 v21, v21, v22
    v_mul_u32_u24 v21, 1280, v21
    v_lshl_add_u32 v145, v16, 4, v21
    v_lshl_add_u32 v21, v19, 1, v18
    v_lshl_add_u32 v21, v20, 2, v21
    v_mul_u32_u24 v21, 20, v21
    v_add3_u32 v21, v21, v17, 16
    v_mul_u32_u24 v21, 1280, v21
    v_lshl_add_u32 v150, v16, 4, v21
    v_add_u32 v14, 128, v1
    v_mul_u32_u24 v15, 6554, v14
    v_lshrrev_b32 v15, 16, v15
    v_mul_u32_u24 v16, 10, v15
    v_sub_u32 v16, v14, v16
    v_and_b32 v17, 3, v15
    v_bfe_u32 v18, v15, 3, 1
    v_bfe_u32 v19, v15, 2, 1
    v_lshrrev_b32 v20, 4, v15
    v_lshl_add_u32 v21, v18, 2, v17
    v_lshl_add_u32 v21, v19, 3, v21
    v_mul_u32_u24 v22, 20, v20
    v_add_u32 v21, v21, v22
    v_mul_u32_u24 v21, 1280, v21
    v_lshl_add_u32 v146, v16, 4, v21
    v_lshl_add_u32 v21, v19, 1, v18
    v_lshl_add_u32 v21, v20, 2, v21
    v_mul_u32_u24 v21, 20, v21
    v_add3_u32 v21, v21, v17, 16
    v_mul_u32_u24 v21, 1280, v21
    v_lshl_add_u32 v151, v16, 4, v21
    v_add_u32 v14, 192, v1
    v_mul_u32_u24 v15, 6554, v14
    v_lshrrev_b32 v15, 16, v15
    v_mul_u32_u24 v16, 10, v15
    v_sub_u32 v16, v14, v16
    v_and_b32 v17, 3, v15
    v_bfe_u32 v18, v15, 3, 1
    v_bfe_u32 v19, v15, 2, 1
    v_lshrrev_b32 v20, 4, v15
    v_lshl_add_u32 v21, v18, 2, v17
    v_lshl_add_u32 v21, v19, 3, v21
    v_mul_u32_u24 v22, 20, v20
    v_add_u32 v21, v21, v22
    v_mul_u32_u24 v21, 1280, v21
    v_lshl_add_u32 v147, v16, 4, v21
    v_lshl_add_u32 v21, v19, 1, v18
    v_lshl_add_u32 v21, v20, 2, v21
    v_mul_u32_u24 v21, 20, v21
    v_add3_u32 v21, v21, v17, 16
    v_mul_u32_u24 v21, 1280, v21
    v_lshl_add_u32 v152, v16, 4, v21
    v_add_u32 v14, 256, v1
    v_mul_u32_u24 v15, 6554, v14
    v_lshrrev_b32 v15, 16, v15
    v_mul_u32_u24 v16, 10, v15
    v_sub_u32 v16, v14, v16
    v_and_b32 v17, 3, v15
    v_bfe_u32 v18, v15, 3, 1
    v_bfe_u32 v19, v15, 2, 1
    v_lshrrev_b32 v20, 4, v15
    v_lshl_add_u32 v21, v18, 2, v17
    v_lshl_add_u32 v21, v19, 3, v21
    v_mul_u32_u24 v22, 20, v20
    v_add_u32 v21, v21, v22
    v_mul_u32_u24 v21, 1280, v21
    v_lshl_add_u32 v148, v16, 4, v21
    v_lshl_add_u32 v21, v19, 1, v18
    v_lshl_add_u32 v21, v20, 2, v21
    v_mul_u32_u24 v21, 20, v21
    v_add3_u32 v21, v21, v17, 16
    v_mul_u32_u24 v21, 1280, v21
    v_lshl_add_u32 v153, v16, 4, v21
    s_mov_b32 s72, 262144
NC_1:
    v_readfirstlane_b32 s62, v12
    s_sub_u32 s72, s72, 1
    s_cmp_lg_u32 s62, 0
    s_cbranch_scc1 NCd_2
    s_cmp_eq_u32 s72, 0
    s_cbranch_scc1 NCd_2
    s_sleep 8
    buffer_load_dword v12, v13, s[48:51], 0 offen sc1
    s_waitcnt vmcnt(0)
    s_branch NC_1
NCd_2:
    s_mov_b32 s64, s62
    s_mov_b32 s65, s62
    s_barrier
    s_branch H_p2
H_nop1:
    s_mov_b32 s36, s14
    s_mov_b32 s37, s15
    s_mov_b32 s38, 19271680
    s_mov_b32 s39, 0x00020000
    s_mov_b32 s48, s12
    s_mov_b32 s49, s13
    s_mov_b32 s50, 256
    s_mov_b32 s51, 0x00020000
    s_mov_b32 s40, s8
    s_mov_b32 s41, s9
    s_mov_b32 s42, 819200
    s_mov_b32 s43, 0x00020000
    s_mov_b32 s44, s10
    s_mov_b32 s45, s11
    s_mov_b32 s46, 2621440
    s_mov_b32 s47, 0x00020000
    s_cmp_lg_u32 s2, 255
    s_cbranch_scc1 H_nogen
    s_cmp_lg_u32 s61, 0
    s_cbranch_scc1 H_nogen
    v_mov_b32 v2, 10616832
    buffer_load_dword v3, v2, s[36:39], 0 offen sc1
    s_waitcnt vmcnt(0)
    v_readfirstlane_b32 s72, v3
    s_mov_b64 exec, 1
    s_mul_i32 s72, s72, 0x9e3779b1
    s_add_u32 s72, s72, 0x7f4a7c15
    s_cmp_eq_u32 s72, 0
    s_cselect_b32 s72, 0x2545f491, s72
    v_mov_b32 v3, s72
    v_mov_b32 v4, 0
    buffer_store_dword v3, v4, s[48:51], 0 offen sc1
    buffer_store_dword v3, v2, s[36:39], 0 offen sc1
    s_mov_b64 exec, -1
H_nogen:
    v_mov_b32 v31, 102400
    s_and_b32 s72, s25, 1
    s_lshl_b32 s73, s24, 1
    s_add_u32 s72, s72, s73
    s_lshr_b32 s75, s25, 1
    s_and_b32 s76, s61, 1
    s_lshl_b32 s71, s72, 1
    s_add_u32 s71, s71, s76
    s_lshr_b32 s77, s61, 1
    s_xor_b32 s78, s63, 1
    s_lshl_b32 s78, s78, 1
    s_lshl_b32 s70, s75, 2
    s_add_u32 s70, s70, s77
    s_lshl_b32 s73, s75, 4
    s_add_u32 s73, s73, s72
    s_lshl_b32 s73, s73, 7
    s_add_u32 s73, s73, 10485760
    s_add_u32 s66, s14, s73
    s_addc_u32 s67, s15, 0
    s_lshl_b32 s73, s24, 3
    s_and_b32 s74, s25, 2
    s_lshl_b32 s74, s74, 1
    s_add_u32 s73, s73, s74
    s_and_b32 s74, s25, 1
    s_add_u32 s73, s73, s74
    s_add_u32 s59, s73, s78
    s_lshl_b32 s73, s59, 3
    s_lshr_b32 s74, s25, 2
    s_add_u32 s73, s73, s74
    s_lshl_b32 s73, s73, 7
    s_lshr_b32 s74, s61, 1
    s_lshl_b32 s74, s74, 6
    s_add_u32 s73, s73, s74
    s_add_u32 s73, s73, 10551296
    s_add_u32 s68, s14, s73
    s_addc_u32 s69, s15, 0
    s_mul_i32 s79, s72, 163840
    s_mul_i32 s3, s70, 2560
    s_add_u32 s3, s3, s79
    s_and_b32 s72, s61, 1
    s_mul_i32 s73, s72, 2621440
    s_add_u32 s73, s73, s79
    s_add_u32 s73, s73, 2621440
    s_add_u32 s52, s14, s73
    s_addc_u32 s53, s15, 0
    s_mov_b32 s54, 163840
    s_mov_b32 s55, 0x00020000
    s_lshl_b32 s73, s75, 2
    s_sub_u32 s73, s73, 8
    s_mul_i32 s73, s73, 2560
    s_lshr_b32 s74, s61, 1
    s_mul_i32 s57, s74, 409600
    s_lshl_b32 s74, s74, 10
    s_add_u32 s73, s73, s74
    v_lshlrev_b32 v14, 4, v1
    v_add_u32 v29, s73, v14
    s_lshr_b32 s73, s25, 2
    s_mul_i32 s73, s73, 160
    s_add_u32 s57, s57, s73
    s_mul_i32 s58, s61, 25600
    s_mov_b32 s56, 0
    v_add_u32 v14, 0, v1
    v_mul_u32_u24 v15, 6554, v14
    v_lshrrev_b32 v15, 16, v15
    v_mul_u32_u24 v16, 10, v15
    v_sub_u32 v16, v14, v16
    v_and_b32 v17, 3, v15
    v_bfe_u32 v18, v15, 3, 1
    v_bfe_u32 v19, v15, 2, 1
    v_lshrrev_b32 v20, 4, v15
    v_lshl_add_u32 v21, v18, 2, v17
    v_lshl_add_u32 v21, v19, 3, v21
    v_mul_u32_u24 v22, 20, v20
    v_add_u32 v21, v21, v22
    v_mul_u32_u24 v21, 1280, v21
    v_lshl_add_u32 v144, v16, 4, v21
    v_lshl_add_u32 v21, v19, 1, v18
    v_lshl_add_u32 v21, v20, 2, v21
    v_mul_u32_u24 v21, 20, v21
    v_add3_u32 v21, v21, v17, 16
    v_mul_u32_u24 v21, 1280, v21
    v_lshl_add_u32 v149, v16, 4, v21
    v_add_u32 v14, 64, v1
    v_mul_u32_u24 v15, 6554, v14
    v_lshrrev_b32 v15, 16, v15
    v_mul_u32_u24 v16, 10, v15
    v_sub_u32 v16, v14, v16
    v_and_b32 v17, 3, v15
    v_bfe_u32 v18, v15, 3, 1
    v_bfe_u32 v19, v15, 2, 1
    v_lshrrev_b32 v20, 4, v15
    v_lshl_add_u32 v21, v18, 2, v17
    v_lshl_add_u32 v21, v19, 3, v21
    v_mul_u32_u24 v22, 20, v20
    v_add_u32 v21, v21, v22
    v_mul_u32_u24 v21, 1280, v21
    v_lshl_add_u32 v145, v16, 4, v21
    v_lshl_add_u32 v21, v19, 1, v18
    v_lshl_add_u32 v21, v20, 2, v21
    v_mul_u32_u24 v21, 20, v21
    v_add3_u32 v21, v21, v17, 16
    v_mul_u32_u24 v21, 1280, v21
    v_lshl_add_u32 v150, v16, 4, v21
    v_add_u32 v14, 128, v1
    v_mul_u32_u24 v15, 6554, v14
    v_lshrrev_b32 v15, 16, v15
    v_mul_u32_u24 v16, 10, v15
    v_sub_u32 v16, v14, v16
    v_and_b32 v17, 3, v15
    v_bfe_u32 v18, v15, 3, 1
    v_bfe_u32 v19, v15, 2, 1
    v_lshrrev_b32 v20, 4, v15
    v_lshl_add_u32 v21, v18, 2, v17
    v_lshl_add_u32 v21, v19, 3, v21
    v_mul_u32_u24 v22, 20, v20
    v_add_u32 v21, v21, v22
    v_mul_u32_u24 v21, 1280, v21
    v_lshl_add_u32 v146, v16, 4, v21
    v_lshl_add_u32 v21, v19, 1, v18
    v_lshl_add_u32 v21, v20, 2, v21
    v_mul_u32_u24 v21, 20, v21
    v_add3_u32 v21, v21, v17, 16
    v_mul_u32_u24 v21, 1280, v21
    v_lshl_add_u32 v151, v16, 4, v21
    v_add_u32 v14, 192, v1
    v_mul_u32_u24 v15, 6554, v14
    v_lshrrev_b32 v15, 16, v15
    v_mul_u32_u24 v16, 10, v15
    v_sub_u32 v16, v14, v16
    v_and_b32 v17, 3, v15
    v_bfe_u32 v18, v15, 3, 1
    v_bfe_u32 v19, v15, 2, 1
    v_lshrrev_b32 v20, 4, v15
    v_lshl_add_u32 v21, v18, 2, v17
    v_lshl_add_u32 v21, v19, 3, v21
    v_mul_u32_u24 v22, 20, v20
    v_add_u32 v21, v21, v22
    v_mul_u32_u24 v21, 1280, v21
    v_lshl_add_u32 v147, v16, 4, v21
    v_lshl_add_u32 v21, v19, 1, v18
    v_lshl_add_u32 v21, v20, 2, v21
    v_mul_u32_u24 v21, 20, v21
    v_add3_u32 v21, v21, v17, 16
    v_mul_u32_u24 v21, 1280, v21
    v_lshl_add_u32 v152, v16, 4, v21
    v_add_u32 v14, 256, v1
    v_mul_u32_u24 v15, 6554, v14
    v_lshrrev_b32 v15, 16, v15
    v_mul_u32_u24 v16, 10, v15
    v_sub_u32 v16, v14, v16
    v_and_b32 v17, 3, v15
    v_bfe_u32 v18, v15, 3, 1
    v_bfe_u32 v19, v15, 2, 1
    v_lshrrev_b32 v20, 4, v15
    v_lshl_add_u32 v21, v18, 2, v17
    v_lshl_add_u32 v21, v19, 3, v21
    v_mul_u32_u24 v22, 20, v20
    v_add_u32 v21, v21, v22
    v_mul_u32_u24 v21, 1280, v21
    v_lshl_add_u32 v148, v16, 4, v21
    v_lshl_add_u32 v21, v19, 1, v18
    v_lshl_add_u32 v21, v20, 2, v21
    v_mul_u32_u24 v21, 20, v21
    v_add3_u32 v21, v21, v17, 16
    v_mul_u32_u24 v21, 1280, v21
    v_lshl_add_u32 v153, v16, 4, v21
L_notile:
    s_barrier
    s_sub_u32 s72, s25, 28
    s_lshl_b32 s72, s72, 2
    s_and_b32 s73, s24, 3
    s_add_u32 s72, s72, s73
    s_lshl_b32 s72, s72, 3
    s_add_u32 s72, s72, s60
    s_mul_i32 s72, s72, 6400
    v_lshlrev_b32 v2, 7, v1
    s_mov_b32 exec_hi, 0x3ffff
    buffer_load_dword v4, v2, s[40:43], s72 offen
    s_mov_b64 exec, -1
    v_mov_b32 v13, 0
    buffer_load_dword v12, v13, s[48:51], 0 offen sc1
    s_waitcnt vmcnt(0)
    s_mov_b32 s72, 262144
NC_3:
    v_readfirstlane_b32 s62, v12
    s_sub_u32 s72, s72, 1
    s_cmp_lg_u32 s62, 0
    s_cbranch_scc1 NCd_4
    s_cmp_eq_u32 s72, 0
    s_cbranch_scc1 NCd_4
    s_sleep 8
    buffer_load_dword v12, v13, s[48:51], 0 offen sc1
    s_waitcnt vmcnt(0)
    s_branch NC_3
NCd_4:
    s_mov_b32 s64, s62
    s_mov_b32 s65, s62
    s_cmp_eq_u32 s63, 0
    s_cbranch_scc1 C_p2
H_p2:
    s_mov_b32 s76, 262144
    s_mov_b32 s74, 7
    s_cmp_lt_u32 s70, 8
    s_cselect_b32 s75, 1, 0
    s_cmp_lt_u32 s70, 4
    s_cselect_b32 s75, 3, s75
    s_and_b32 s72, s61, 1
    s_mul_i32 s77, s72, 30720
    s_mul_i32 s72, s72, 24
    s_add_u32 s34, s66, s72
    s_addc_u32 s35, s67, 0
    s_lshr_b32 s72, s61, 1
    s_lshl_b32 s72, s72, 10
    s_add_u32 s77, s77, s72
    s_add_u32 s77, s77, 102400
    s_mul_i32 s33, s75, 0
    s_and_b32 s72, s61, 1
    s_mul_i32 s33, s72, 3
    s_lshl_b32 s72, s75, 3
    s_or_b32 s75, s75, s72
    s_mov_b32 s32, 0
    s_lshr_b32 s72, s71, 1
    s_mul_i32 s72, s72, 40
    s_add_u32 s73, s72, 39
    s_xor_b32 s72, s72, s73
    s_lshr_b32 s31, s72, 7
    s_cmp_eq_u32 s31, 0
    s_cselect_b32 s30, 0x2aaa, 0
    s_sub_u32 s72, s66, s36
    v_lshlrev_b32 v5, 2, v1
    v_add_u32 v5, s72, v5
    s_mov_b64 s[4:5], 0
    s_mov_b64 s[6:7], 0
    s_mov_b64 s[8:9], 0
    s_mov_b64 s[10:11], 0
    s_mov_b64 s[12:13], 0
    s_mov_b64 s[14:15], 0
    s_mov_b64 s[16:17], 0
    s_branch H_p1
H_p1s:
    s_sleep 0
H_p1:
    s_cmp_lg_u32 s61, 0
    s_cbranch_scc1 H_lds
    s_load_dwordx16 s[4:19], s[66:67], 0 glc
    s_sub_u32 s76, s76, 1
    s_cselect_b32 s78, 0x7f, s75
    s_or_b32 s78, s78, s32
    s_waitcnt lgkmcnt(0)
    s_cmp_lg_u32 s31, 0
    s_cbranch_scc1 H_two
    s_mov_b32 s5, s62
    s_mov_b32 s7, s62
    s_mov_b32 s9, s62
    s_mov_b32 s11, s62
    s_mov_b32 s13, s62
    s_mov_b32 s15, s62
    s_mov_b32 s17, s62
H_two:
    s_cmp_eq_u64 s[4:5], s[64:65]
    s_cselect_b32 s72, 1, 0
    s_or_b32 s78, s78, s72
    s_cmp_eq_u64 s[6:7], s[64:65]
    s_cselect_b32 s72, 2, 0
    s_or_b32 s78, s78, s72
    s_cmp_eq_u64 s[8:9], s[64:65]
    s_cselect_b32 s72, 4, 0
    s_or_b32 s78, s78, s72
    s_cmp_eq_u64 s[10:11], s[64:65]
    s_cselect_b32 s72, 8, 0
    s_or_b32 s78, s78, s72
    s_cmp_eq_u64 s[12:13], s[64:65]
    s_cselect_b32 s72, 16, 0
    s_or_b32 s78, s78, s72
    s_cmp_eq_u64 s[14:15], s[64:65]
    s_cselect_b32 s72, 32, 0
    s_or_b32 s78, s78, s72
    s_cmp_eq_u64 s[16:17], s[64:65]
    s_cselect_b32 s72, 64, 0
    s_or_b32 s78, s78, s72
    s_cmp_eq_u32 s78, s32
    s_cbranch_scc1 H_p1s
    s_mov_b32 s32, s78
    v_mov_b32 v3, s78
    s_mov_b64 exec, 1
    ds_write_b32 v31, v3 offset:8
    s_mov_b64 exec, -1
    s_branch H_got
H_lds:
    s_sleep 1
    ds_read_b32 v30, v31 offset:8
    s_waitcnt lgkmcnt(0)
    v_readfirstlane_b32 s78, v30
    s_nop 0
H_got:
    s_lshr_b32 s78, s78, s33
    s_and_b32 s78, s78, s74
    s_cbranch_scc0 H_p1x
H_p1n:
    s_ff1_i32_b32 s79, s78
    s_bitset0_b32 s74, s79
    s_bitset0_b32 s78, s79
    s_or_b32 s72, s79, s61
    s_cmp_eq_u32 s72, 0
    s_cselect_b32 s72, -2, -1
    s_mul_i32 s79, s79, 10240
    v_add_u32 v2, s79, v29
    s_add_u32 s79, s79, s77
    s_mov_b32 m0, s79
    s_mov_b32 exec_lo, s72
    buffer_load_dwordx4 v2, s[52:55], 0 offen sc1 lds
    s_mov_b64 exec, -1
    s_add_u32 m0, s79, 2048
    v_add_u32 v2, 2048, v2
    buffer_load_dwordx4 v2, s[52:55], 0 offen sc1 lds
    s_add_u32 m0, s79, 4096
    v_add_u32 v2, 2048, v2
    buffer_load_dwordx4 v2, s[52:55], 0 offen sc1 lds
    s_add_u32 m0, s79, 6144
    v_add_u32 v2, 2048, v2
    buffer_load_dwordx4 v2, s[52:55], 0 offen sc1 lds
    s_add_u32 m0, s79, 8192
    v_add_u32 v2, 2048, v2
    buffer_load_dwordx4 v2, s[52:55], 0 offen sc1 lds
    s_cmp_lg_u32 s78, 0
    s_cbranch_scc1 H_p1n
H_p1x:
    s_cmp_lg_u32 s74, 0
    s_cbranch_scc1 H_p1
    s_cmp_lg_u32 s61, 0
    s_cbranch_scc1 H_p1e
    s_cmp_lg_u32 s32, 0x7f
    s_cbranch_scc1 H_p1
H_p1e:
    s_waitcnt vmcnt(0) lgkmcnt(0)
    s_barrier
H_wo:
    s_and_b32 s72, s61, 1
    s_mul_i32 s72, s72, 5
    s_add_u32 s72, s72, s56
    s_mul_i32 s73, s56, 5120
    s_add_u32 s73, s73, s58
    s_add_u32 s56, s56, 1
    s_cmp_ge_u32 s72, 8
    s_cbranch_scc1 WOI_r
    s_mul_i32 s72, s72, 51200
    s_add_u32 s72, s72, s57
    s_add_u32 m0, s73, 0
    s_nop 0
    buffer_load_dwordx4 v144, s[40:43], s72 offen lds
    s_add_u32 m0, s73, 1024
    s_nop 0
    buffer_load_dwordx4 v145, s[40:43], s72 offen lds
    s_add_u32 m0, s73, 2048
    s_nop 0
    buffer_load_dwordx4 v146, s[40:43], s72 offen lds
    s_add_u32 m0, s73, 3072
    s_nop 0
    buffer_load_dwordx4 v147, s[40:43], s72 offen lds
    s_add_u32 m0, s73, 4096
    s_nop 0
    buffer_load_dwordx4 v148, s[40:43], s72 offen lds
    s_branch WOI_e
WOI_r:
    s_sub_u32 s72, s72, 8
    s_mul_i32 s72, s72, 204800
    s_add_u32 s72, s72, s57
    s_add_u32 m0, s73, 0
    s_nop 0
    buffer_load_dwordx4 v149, s[40:43], s72 offen lds
    s_add_u32 m0, s73, 1024
    s_nop 0
    buffer_load_dwordx4 v150, s[40:43], s72 offen lds
    s_add_u32 m0, s73, 2048
    s_nop 0
    buffer_load_dwordx4 v151, s[40:43], s72 offen lds
    s_add_u32 m0, s73, 3072
    s_nop 0
    buffer_load_dwordx4 v152, s[40:43], s72 offen lds
    s_add_u32 m0, s73, 4096
    s_nop 0
    buffer_load_dwordx4 v153, s[40:43], s72 offen lds
WOI_e:
    s_cmp_lt_u32 s56, 5
    s_cbranch_scc1 H_wo
    v_mov_b32 v3, 16
    s_waitcnt vmcnt(0)
    s_mov_b64 exec, 1
    ds_add_u32 v31, v3 offset:0
    s_mov_b64 exec, -1
    s_branch L_p3
L_compute:
    s_mov_b32 s63, 0
    s_mov_b32 s56, 5
    v_mov_b32 v16, 102400
    v_mov_b32 v36, 0
    v_mov_b32 v37, 0
    v_mov_b32 v38, 0
    v_mov_b32 v39, 0
    ds_write_b128 v16, v[36:39]
    v_and_b32 v34, 31, v1
    v_lshrrev_b32 v35, 5, v1
    v_lshrrev_b32 v36, 1, v34
    v_and_b32 v36, 7, v36
    v_xor_b32 v36, v36, v35
    v_lshlrev_b32 v36, 4, v36
    v_lshl_add_u32 v2, v34, 7, v36
    v_xor_b32 v3, 32, v2
    v_xor_b32 v4, 64, v2
    v_xor_b32 v5, 96, v2
    v_and_b32 v36, 1, v1
    v_lshlrev_b32 v36, 1, v36
    v_bfe_u32 v37, v1, 1, 1
    v_or_b32 v36, v36, v37
    v_bfe_u32 v37, v1, 4, 1
    v_lshl_or_b32 v36, v37, 2, v36
    s_lshl_b32 s72, s61, 3
    v_or_b32 v36, s72, v36
    v_bfe_u32 v37, v1, 2, 2
    v_lshlrev_b32 v38, 3, v37
    v_xor_b32 v36, v36, v38
    v_lshl_add_u32 v37, v35, 3, v37
    v_lshlrev_b32 v37, 8, v37
    v_lshl_add_u32 v10, v36, 3, v37
    v_add_u32 v11, 57344, v10
    v_add_u32 v6, 57344, v2
    v_add_u32 v7, 57344, v3
    v_add_u32 v8, 57344, v4
    v_add_u32 v9, 57344, v5
    s_getpc_b64 s[52:53]
L_pc:
    s_sub_u32 s52, s52, L_pc-L_start
    s_subb_u32 s53, s53, 0
    s_mov_b32 s54, L_code_end-L_start
    s_mov_b32 s55, 0x00020000
    s_and_b32 s72, s25, 3
    s_lshl_b32 s72, s72, 2
    s_add_u32 s72, s72, s61
    s_mul_i32 s72, s72, 1536
    v_lshlrev_b32 v36, 7, v1
    s_mov_b64 exec, 0xfff
    buffer_load_dword v0, v36, s[52:55], s72 offen
    s_mov_b64 exec, -1
    s_waitcnt lgkmcnt(0)
    s_add_u32 s14, s14, 67108864
    s_addc_u32 s15, s15, 0
    s_mov_b32 s36, s14
    s_mov_b32 s37, s15
    s_mov_b32 s38, 19271680
    s_mov_b32 s39, 0x00020000
    s_mov_b32 s48, s12
    s_mov_b32 s49, s13
    s_mov_b32 s50, 256
    s_mov_b32 s51, 0x00020000
    s_mov_b32 s40, s8
    s_mov_b32 s41, s9
    s_mov_b32 s42, 819200
    s_mov_b32 s43, 0x00020000
    s_mov_b32 s44, s10
    s_mov_b32 s45, s11
    s_mov_b32 s46, 2621440
    s_mov_b32 s47, 0x00020000
    s_cmp_ge_u32 s3, 60
    s_cbranch_scc1 L_notile
    s_mul_i32 s72, s28, 10240
    s_cmp_ge_u32 s29, 5
    s_cselect_b32 s32, 1, 0
    s_cmp_ge_u32 s29, 10
    s_cselect_b32 s32, 2, s32
    s_mul_i32 s73, s32, 5
    s_sub_u32 s31, s29, s73
    s_mul_i32 s34, s32, 2621440
    s_add_u32 s34, s34, s72
    s_add_u32 s35, s34, 5120
    s_lshl_b32 s33, s31, 2
    s_add_u32 s33, s33, s61
    s_cmp_eq_u32 s32, 2
    s_cbranch_scc1 C_addrV
    s_lshl_b32 s73, s33, 2
    v_add_u32 v38, s73, v35
    v_lshlrev_b32 v37, 4, v34
    v_add_u32 v39, 0, v38
    v_mul_u32_u24 v40, 205, v39
    v_lshrrev_b32 v40, 10, v40
    v_mul_u32_u24 v41, 5, v40
    v_sub_u32 v41, v39, v41
    v_mul_u32_u24 v40, 163840, v40
    v_lshl_add_u32 v40, v41, 9, v40
    v_add_u32 v12, v40, v37
    v_add_u32 v39, 2, v38
    v_mul_u32_u24 v40, 205, v39
    v_lshrrev_b32 v40, 10, v40
    v_mul_u32_u24 v41, 5, v40
    v_sub_u32 v41, v39, v41
    v_mul_u32_u24 v40, 163840, v40
    v_lshl_add_u32 v40, v41, 9, v40
    v_add_u32 v13, v40, v37
    s_branch C_addrdone
C_addrV:
    v_and_b32 v42, 0x13, v34
    v_bfe_u32 v43, v34, 2, 1
    v_lshl_or_b32 v42, v43, 3, v42
    v_bfe_u32 v43, v34, 3, 1
    v_lshl_or_b32 v42, v43, 2, v42
    s_lshl_b32 s73, s33, 5
    v_add_u32 v39, s73, v42
    v_mul_u32_u24 v37, 640, v35
    v_mul_u32_u24 v40, 1639, v39
    v_lshrrev_b32 v40, 16, v40
    v_mul_u32_u24 v41, 40, v40
    v_sub_u32 v41, v39, v41
    v_mul_u32_u24 v40, 163840, v40
    v_lshl_add_u32 v40, v41, 4, v40
    v_add_u32 v12, v40, v37
    v_add_u32 v13, 1280, v12
C_addrdone:
    s_mul_i32 s72, s31, 205
    s_lshr_b32 s72, s72, 6
    v_bfe_u32 v38, v1, 1, 2
    v_add_u32 v38, s72, v38
    v_mul_u32_u24 v39, 40, v38
    v_add_u32 v40, 39, v39
    v_lshrrev_b32 v39, 7, v39
    v_lshrrev_b32 v40, 7, v40
    v_and_b32 v41, 1, v1
    v_cmp_eq_u32 vcc, 1, v41
    v_lshrrev_b32 v42, 3, v1
    v_lshlrev_b32 v43, 1, v42
    v_cmp_eq_u32 s[72:73], v39, v40
    v_cndmask_b32 v39, v39, v40, vcc
    s_and_b64 s[72:73], s[72:73], vcc
    v_cmp_eq_u32 s[26:27], s31, v39
    s_nop 0
    s_andn2_b64 s[26:27], s[26:27], s[72:73]
    v_sub_u32 v42, 2, v42
    v_add_u32 v42, s28, v42
    v_cmp_gt_u32 vcc, 16, v42
    s_and_b64 s[26:27], s[26:27], vcc
    s_cmp_eq_u32 s32, 0
    s_cselect_b32 s73, 0xff0000, -1
    s_and_b32 s26, s26, s73
    s_and_b32 s26, s26, 0xffffff
    s_mov_b32 s27, 0
    s_mul_i32 s73, s32, 6
    s_sub_u32 s73, s73, 6
    s_cmp_eq_u32 s32, 0
    s_cselect_b32 s73, 8, s73
    v_add3_u32 v41, v41, v43, s73
    v_lshl_add_u32 v42, v42, 4, v38
    v_lshlrev_b32 v42, 7, v42
    v_lshl_add_u32 v14, v41, 2, v42
    s_cselect_b32 s28, 1051011932, 1.0
    s_mov_b32 s29, s28
    s_cmp_eq_u32 s32, 2
    s_cbranch_scc1 C_gemmV
.p2align 3
C_gemmQK:
    s_barrier
    s_nop 0
    ds_read_b64_tr_b16 v[96:97], v10 offset:12288
    ds_read_b64_tr_b16 v[98:99], v10 offset:13312
    ds_read_b128 v[16:19], v2 offset:0
    ds_read_b128 v[20:23], v2 offset:4096
    ds_read_b128 v[24:27], v2 offset:8192
    s_waitcnt lgkmcnt(2)
    s_nop 0
    v_mfma_f32_32x32x16_bf16 v[48:63], v[96:99], v[16:19], 0
    ds_read_b64_tr_b16 v[100:101], v10 offset:16384
    ds_read_b64_tr_b16 v[102:103], v10 offset:17408
    ds_read_b128 v[28:31], v3 offset:0
    s_waitcnt lgkmcnt(4)
    s_nop 0
    v_mfma_f32_32x32x16_bf16 v[64:79], v[96:99], v[20:23], 0
    ds_read_b128 v[32:35], v3 offset:4096
    ds_read_b128 v[36:39], v3 offset:8192
    ds_read_b64_tr_b16 v[104:105], v10 offset:20480
    s_waitcnt lgkmcnt(6)
    s_nop 0
    v_mfma_f32_32x32x16_bf16 v[80:95], v[96:99], v[24:27], 0
    ds_read_b64_tr_b16 v[106:107], v10 offset:21504
    ds_read_b128 v[40:43], v4 offset:0
    ds_read_b128 v[44:47], v4 offset:4096
    s_waitcnt lgkmcnt(4)
    s_nop 0
    v_mfma_f32_32x32x16_bf16 v[48:63], v[100:103], v[28:31], v[48:63]
    ds_read_b128 v[16:19], v4 offset:8192
    ds_read_b64_tr_b16 v[108:109], v10 offset:24576
    ds_read_b64_tr_b16 v[110:111], v10 offset:25600
    v_mfma_f32_32x32x16_bf16 v[64:79], v[100:103], v[32:35], v[64:79]
    ds_read_b128 v[20:23], v5 offset:0
    ds_read_b128 v[24:27], v5 offset:4096
    ds_read_b128 v[28:31], v5 offset:8192
    v_mfma_f32_32x32x16_bf16 v[80:95], v[100:103], v[36:39], v[80:95]
    s_waitcnt lgkmcnt(5)
    s_nop 0
    v_mfma_f32_32x32x16_bf16 v[48:63], v[104:107], v[40:43], v[48:63]
    v_mfma_f32_32x32x16_bf16 v[64:79], v[104:107], v[44:47], v[64:79]
    s_waitcnt lgkmcnt(0)
    s_barrier
    v_mfma_f32_32x32x16_bf16 v[80:95], v[104:107], v[16:19], v[80:95]
    ds_read_b64_tr_b16 v[112:113], v10 offset:40960
    ds_read_b64_tr_b16 v[114:115], v10 offset:41984
    ds_read_b128 v[32:35], v2 offset:28672
    v_mfma_f32_32x32x16_bf16 v[48:63], v[108:111], v[20:23], v[48:63]
    ds_read_b128 v[36:39], v2 offset:32768
    ds_read_b128 v[40:43], v2 offset:36864
    ds_read_b64_tr_b16 v[116:117], v10 offset:45056
    v_mfma_f32_32x32x16_bf16 v[64:79], v[108:111], v[24:27], v[64:79]
    ds_read_b64_tr_b16 v[118:119], v10 offset:46080
    ds_read_b128 v[44:47], v3 offset:28672
    ds_read_b128 v[16:19], v3 offset:32768
    v_mfma_f32_32x32x16_bf16 v[80:95], v[108:111], v[28:31], v[80:95]
    ds_read_b128 v[20:23], v3 offset:36864
    ds_read_b64_tr_b16 v[120:121], v10 offset:49152
    ds_read_b64_tr_b16 v[122:123], v10 offset:50176
    s_waitcnt lgkmcnt(7)
    s_nop 0
    v_mfma_f32_32x32x16_bf16 v[48:63], v[112:115], v[32:35], v[48:63]
    ds_read_b128 v[24:27], v4 offset:28672
    ds_read_b128 v[28:31], v4 offset:32768
    ds_read_b128 v[32:35], v4 offset:36864
    v_mfma_f32_32x32x16_bf16 v[64:79], v[112:115], v[36:39], v[64:79]
    ds_read_b64_tr_b16 v[124:125], v10 offset:53248
    ds_read_b64_tr_b16 v[126:127], v10 offset:54272
    ds_read_b128 v[36:39], v5 offset:28672
    v_mfma_f32_32x32x16_bf16 v[80:95], v[112:115], v[40:43], v[80:95]
    ds_read_b128 v[40:43], v5 offset:32768
    s_waitcnt lgkmcnt(9)
    s_nop 0
    v_mfma_f32_32x32x16_bf16 v[48:63], v[116:119], v[44:47], v[48:63]
    ds_read_b128 v[44:47], v5 offset:36864
    v_mfma_f32_32x32x16_bf16 v[64:79], v[116:119], v[16:19], v[64:79]
    v_mfma_f32_32x32x16_bf16 v[80:95], v[116:119], v[20:23], v[80:95]
    s_waitcnt lgkmcnt(5)
    s_nop 0
    v_mfma_f32_32x32x16_bf16 v[48:63], v[120:123], v[24:27], v[48:63]
    v_mfma_f32_32x32x16_bf16 v[64:79], v[120:123], v[28:31], v[64:79]
    s_waitcnt lgkmcnt(0)
    s_barrier
    v_mfma_f32_32x32x16_bf16 v[80:95], v[120:123], v[32:35], v[80:95]
    ds_read_b64_tr_b16 v[128:129], v11 offset:12288
    ds_read_b64_tr_b16 v[130:131], v11 offset:13312
    ds_read_b128 v[16:19], v6 offset:0
    v_mfma_f32_32x32x16_bf16 v[48:63], v[124:127], v[36:39], v[48:63]
    ds_read_b128 v[20:23], v6 offset:4096
    ds_read_b128 v[24:27], v6 offset:8192
    ds_read_b64_tr_b16 v[132:133], v11 offset:16384
    v_mfma_f32_32x32x16_bf16 v[64:79], v[124:127], v[40:43], v[64:79]
    ds_read_b64_tr_b16 v[134:135], v11 offset:17408
    ds_read_b128 v[28:31], v7 offset:0
    ds_read_b128 v[32:35], v7 offset:4096
    v_mfma_f32_32x32x16_bf16 v[80:95], v[124:127], v[44:47], v[80:95]
    ds_read_b128 v[36:39], v7 offset:8192
    ds_read_b64_tr_b16 v[136:137], v11 offset:20480
    ds_read_b64_tr_b16 v[138:139], v11 offset:21504
    s_waitcnt lgkmcnt(7)
    s_nop 0
    v_mfma_f32_32x32x16_bf16 v[48:63], v[128:131], v[16:19], v[48:63]
    ds_read_b128 v[40:43], v8 offset:0
    ds_read_b128 v[44:47], v8 offset:4096
    ds_read_b128 v[16:19], v8 offset:8192
    v_mfma_f32_32x32x16_bf16 v[64:79], v[128:131], v[20:23], v[64:79]
    ds_read_b64_tr_b16 v[140:141], v11 offset:24576
    ds_read_b64_tr_b16 v[142:143], v11 offset:25600
    ds_read_b128 v[20:23], v9 offset:0
    v_mfma_f32_32x32x16_bf16 v[80:95], v[128:131], v[24:27], v[80:95]
    ds_read_b128 v[24:27], v9 offset:4096
    s_waitcnt lgkmcnt(9)
    s_nop 0
    v_mfma_f32_32x32x16_bf16 v[48:63], v[132:135], v[28:31], v[48:63]
    ds_read_b128 v[28:31], v9 offset:8192
    v_mfma_f32_32x32x16_bf16 v[64:79], v[132:135], v[32:35], v[64:79]
    v_mfma_f32_32x32x16_bf16 v[80:95], v[132:135], v[36:39], v[80:95]
    s_waitcnt lgkmcnt(5)
    s_nop 0
    v_mfma_f32_32x32x16_bf16 v[48:63], v[136:139], v[40:43], v[48:63]
    v_mfma_f32_32x32x16_bf16 v[64:79], v[136:139], v[44:47], v[64:79]
    s_waitcnt lgkmcnt(0)
    s_barrier
    v_mfma_f32_32x32x16_bf16 v[80:95], v[136:139], v[16:19], v[80:95]
    ds_read_b64_tr_b16 v[144:145], v10 offset:12288
    ds_read_b64_tr_b16 v[146:147], v10 offset:13312
    ds_read_b128 v[32:35], v2 offset:0
    v_mfma_f32_32x32x16_bf16 v[48:63], v[140:143], v[20:23], v[48:63]
    ds_read_b128 v[36:39], v2 offset:4096
    ds_read_b128 v[40:43], v2 offset:8192
    ds_read_b64_tr_b16 v[148:149], v10 offset:16384
    v_mfma_f32_32x32x16_bf16 v[64:79], v[140:143], v[24:27], v[64:79]
    ds_read_b64_tr_b16 v[150:151], v10 offset:17408
    ds_read_b128 v[44:47], v3 offset:0
    ds_read_b128 v[16:19], v3 offset:4096
    v_mfma_f32_32x32x16_bf16 v[80:95], v[140:143], v[28:31], v[80:95]
    ds_read_b128 v[20:23], v3 offset:8192
    ds_read_b64_tr_b16 v[152:153], v10 offset:20480
    ds_read_b64_tr_b16 v[154:155], v10 offset:21504
    s_waitcnt lgkmcnt(7)
    s_nop 0
    v_mfma_f32_32x32x16_bf16 v[48:63], v[144:147], v[32:35], v[48:63]
    ds_read_b128 v[24:27], v4 offset:0
    ds_read_b128 v[28:31], v4 offset:4096
    ds_read_b128 v[32:35], v4 offset:8192
    v_mfma_f32_32x32x16_bf16 v[64:79], v[144:147], v[36:39], v[64:79]
    ds_read_b64_tr_b16 v[156:157], v10 offset:24576
    ds_read_b64_tr_b16 v[158:159], v10 offset:25600
    ds_read_b128 v[36:39], v5 offset:0
    v_mfma_f32_32x32x16_bf16 v[80:95], v[144:147], v[40:43], v[80:95]
    ds_read_b128 v[40:43], v5 offset:4096
    s_waitcnt lgkmcnt(9)
    s_nop 0
    v_mfma_f32_32x32x16_bf16 v[48:63], v[148:151], v[44:47], v[48:63]
    ds_read_b128 v[44:47], v5 offset:8192
    v_mfma_f32_32x32x16_bf16 v[64:79], v[148:151], v[16:19], v[64:79]
    v_mfma_f32_32x32x16_bf16 v[80:95], v[148:151], v[20:23], v[80:95]
    s_waitcnt lgkmcnt(5)
    s_nop 0
    v_mfma_f32_32x32x16_bf16 v[48:63], v[152:155], v[24:27], v[48:63]
    v_mfma_f32_32x32x16_bf16 v[64:79], v[152:155], v[28:31], v[64:79]
    s_waitcnt lgkmcnt(0)
    s_barrier
    v_mfma_f32_32x32x16_bf16 v[80:95], v[152:155], v[32:35], v[80:95]
    ds_read_b64_tr_b16 v[160:161], v10 offset:40960
    ds_read_b64_tr_b16 v[162:163], v10 offset:41984
    ds_read_b128 v[16:19], v2 offset:28672
    v_mfma_f32_32x32x16_bf16 v[48:63], v[156:159], v[36:39], v[48:63]
    ds_read_b128 v[20:23], v2 offset:32768
    ds_read_b128 v[24:27], v2 offset:36864
    ds_read_b64_tr_b16 v[164:165], v10 offset:45056
    v_mfma_f32_32x32x16_bf16 v[64:79], v[156:159], v[40:43], v[64:79]
    ds_read_b64_tr_b16 v[166:167], v10 offset:46080
    ds_read_b128 v[28:31], v3 offset:28672
    ds_read_b128 v[32:35], v3 offset:32768
    v_mfma_f32_32x32x16_bf16 v[80:95], v[156:159], v[44:47], v[80:95]
    ds_read_b128 v[36:39], v3 offset:36864
    ds_read_b64_tr_b16 v[168:169], v10 offset:49152
    ds_read_b64_tr_b16 v[170:171], v10 offset:50176
    s_waitcnt lgkmcnt(7)
    s_nop 0
    v_mfma_f32_32x32x16_bf16 v[48:63], v[160:163], v[16:19], v[48:63]
    ds_read_b128 v[40:43], v4 offset:28672
    ds_read_b128 v[44:47], v4 offset:32768
    ds_read_b128 v[16:19], v4 offset:36864
    v_mfma_f32_32x32x16_bf16 v[64:79], v[160:163], v[20:23], v[64:79]
    ds_read_b64_tr_b16 v[172:173], v10 offset:53248
    ds_read_b64_tr_b16 v[174:175], v10 offset:54272
    ds_read_b128 v[20:23], v5 offset:28672
    v_mfma_f32_32x32x16_bf16 v[80:95], v[160:163], v[24:27], v[80:95]
    ds_read_b128 v[24:27], v5 offset:32768
    s_waitcnt lgkmcnt(9)
    s_nop 0
    v_mfma_f32_32x32x16_bf16 v[48:63], v[164:167], v[28:31], v[48:63]
    ds_read_b128 v[28:31], v5 offset:36864
    v_mfma_f32_32x32x16_bf16 v[64:79], v[164:167], v[32:35], v[64:79]
    v_mfma_f32_32x32x16_bf16 v[80:95], v[164:167], v[36:39], v[80:95]
    s_waitcnt lgkmcnt(5)
    s_nop 0
    v_mfma_f32_32x32x16_bf16 v[48:63], v[168:171], v[40:43], v[48:63]
    v_mfma_f32_32x32x16_bf16 v[64:79], v[168:171], v[44:47], v[64:79]
    s_waitcnt lgkmcnt(0)
    s_barrier
    v_mfma_f32_32x32x16_bf16 v[80:95], v[168:171], v[16:19], v[80:95]
    ds_read_b64_tr_b16 v[176:177], v11 offset:12288
    ds_read_b64_tr_b16 v[178:179], v11 offset:13312
    ds_read_b128 v[32:35], v6 offset:0
    v_mfma_f32_32x32x16_bf16 v[48:63], v[172:175], v[20:23], v[48:63]
    ds_read_b128 v[36:39], v6 offset:4096
    ds_read_b128 v[40:43], v6 offset:8192
    ds_read_b64_tr_b16 v[180:181], v11 offset:16384
    v_mfma_f32_32x32x16_bf16 v[64:79], v[172:175], v[24:27], v[64:79]
    ds_read_b64_tr_b16 v[182:183], v11 offset:17408
    ds_read_b128 v[44:47], v7 offset:0
    ds_read_b128 v[16:19], v7 offset:4096
    v_mfma_f32_32x32x16_bf16 v[80:95], v[172:175], v[28:31], v[80:95]
    ds_read_b128 v[20:23], v7 offset:8192
    ds_read_b64_tr_b16 v[184:185], v11 offset:20480
    ds_read_b64_tr_b16 v[186:187], v11 offset:21504
    s_waitcnt lgkmcnt(7)
    s_nop 0
    v_mfma_f32_32x32x16_bf16 v[48:63], v[176:179], v[32:35], v[48:63]
    ds_read_b128 v[24:27], v8 offset:0
    ds_read_b128 v[28:31], v8 offset:4096
    ds_read_b128 v[32:35], v8 offset:8192
    v_mfma_f32_32x32x16_bf16 v[64:79], v[176:179], v[36:39], v[64:79]
    ds_read_b64_tr_b16 v[188:189], v11 offset:24576
    ds_read_b64_tr_b16 v[190:191], v11 offset:25600
    ds_read_b128 v[36:39], v9 offset:0
    v_mfma_f32_32x32x16_bf16 v[80:95], v[176:179], v[40:43], v[80:95]
    ds_read_b128 v[40:43], v9 offset:4096
    s_waitcnt lgkmcnt(9)
    s_nop 0
    v_mfma_f32_32x32x16_bf16 v[48:63], v[180:183], v[44:47], v[48:63]
    ds_read_b128 v[44:47], v9 offset:8192
    v_mfma_f32_32x32x16_bf16 v[64:79], v[180:183], v[16:19], v[64:79]
    v_mfma_f32_32x32x16_bf16 v[80:95], v[180:183], v[20:23], v[80:95]
    s_waitcnt lgkmcnt(5)
    s_nop 0
    v_mfma_f32_32x32x16_bf16 v[48:63], v[184:187], v[24:27], v[48:63]
    v_mfma_f32_32x32x16_bf16 v[64:79], v[184:187], v[28:31], v[64:79]
    s_waitcnt lgkmcnt(0)
    s_barrier
    v_mfma_f32_32x32x16_bf16 v[80:95], v[184:187], v[32:35], v[80:95]
    ds_read_b64_tr_b16 v[192:193], v10 offset:12288
    ds_read_b64_tr_b16 v[194:195], v10 offset:13312
    ds_read_b128 v[16:19], v2 offset:0
    v_mfma_f32_32x32x16_bf16 v[48:63], v[188:191], v[36:39], v[48:63]
    ds_read_b128 v[20:23], v2 offset:4096
    ds_read_b128 v[24:27], v2 offset:8192
    ds_read_b64_tr_b16 v[196:197], v10 offset:16384
    v_mfma_f32_32x32x16_bf16 v[64:79], v[188:191], v[40:43], v[64:79]
    ds_read_b64_tr_b16 v[198:199], v10 offset:17408
    ds_read_b128 v[28:31], v3 offset:0
    ds_read_b128 v[32:35], v3 offset:4096
    v_mfma_f32_32x32x16_bf16 v[80:95], v[188:191], v[44:47], v[80:95]
    ds_read_b128 v[36:39], v3 offset:8192
    ds_read_b64_tr_b16 v[200:201], v10 offset:20480
    ds_read_b64_tr_b16 v[202:203], v10 offset:21504
    s_waitcnt lgkmcnt(7)
    s_nop 0
    v_mfma_f32_32x32x16_bf16 v[48:63], v[192:195], v[16:19], v[48:63]
    ds_read_b128 v[40:43], v4 offset:0
    ds_read_b128 v[44:47], v4 offset:4096
    ds_read_b128 v[16:19], v4 offset:8192
    v_mfma_f32_32x32x16_bf16 v[64:79], v[192:195], v[20:23], v[64:79]
    ds_read_b64_tr_b16 v[204:205], v10 offset:24576
    ds_read_b64_tr_b16 v[206:207], v10 offset:25600
    ds_read_b128 v[20:23], v5 offset:0
    v_mfma_f32_32x32x16_bf16 v[80:95], v[192:195], v[24:27], v[80:95]
    ds_read_b128 v[24:27], v5 offset:4096
    s_waitcnt lgkmcnt(9)
    s_nop 0
    v_mfma_f32_32x32x16_bf16 v[48:63], v[196:199], v[28:31], v[48:63]
    ds_read_b128 v[28:31], v5 offset:8192
    v_mfma_f32_32x32x16_bf16 v[64:79], v[196:199], v[32:35], v[64:79]
    v_mfma_f32_32x32x16_bf16 v[80:95], v[196:199], v[36:39], v[80:95]
    s_waitcnt lgkmcnt(5)
    s_nop 0
    v_mfma_f32_32x32x16_bf16 v[48:63], v[200:203], v[40:43], v[48:63]
    v_mfma_f32_32x32x16_bf16 v[64:79], v[200:203], v[44:47], v[64:79]
    s_waitcnt lgkmcnt(0)
    s_barrier
    v_mfma_f32_32x32x16_bf16 v[80:95], v[200:203], v[16:19], v[80:95]
    ds_read_b64_tr_b16 v[208:209], v10 offset:40960
    ds_read_b64_tr_b16 v[210:211], v10 offset:41984
    ds_read_b128 v[32:35], v2 offset:28672
    v_mfma_f32_32x32x16_bf16 v[48:63], v[204:207], v[20:23], v[48:63]
    ds_read_b128 v[36:39], v2 offset:32768
    ds_read_b128 v[40:43], v2 offset:36864
    ds_read_b64_tr_b16 v[212:213], v10 offset:45056
    v_mfma_f32_32x32x16_bf16 v[64:79], v[204:207], v[24:27], v[64:79]
    ds_read_b64_tr_b16 v[214:215], v10 offset:46080
    ds_read_b128 v[44:47], v3 offset:28672
    ds_read_b128 v[16:19], v3 offset:32768
    v_mfma_f32_32x32x16_bf16 v[80:95], v[204:207], v[28:31], v[80:95]
    ds_read_b128 v[20:23], v3 offset:36864
    ds_read_b64_tr_b16 v[216:217], v10 offset:49152
    ds_read_b64_tr_b16 v[218:219], v10 offset:50176
    s_waitcnt lgkmcnt(7)
    s_nop 0
    v_mfma_f32_32x32x16_bf16 v[48:63], v[208:211], v[32:35], v[48:63]
    ds_read_b128 v[24:27], v4 offset:28672
    ds_read_b128 v[28:31], v4 offset:32768
    ds_read_b128 v[32:35], v4 offset:36864
    v_mfma_f32_32x32x16_bf16 v[64:79], v[208:211], v[36:39], v[64:79]
    ds_read_b64_tr_b16 v[220:221], v10 offset:53248
    ds_read_b64_tr_b16 v[222:223], v10 offset:54272
    ds_read_b128 v[36:39], v5 offset:28672
    v_mfma_f32_32x32x16_bf16 v[80:95], v[208:211], v[40:43], v[80:95]
    ds_read_b128 v[40:43], v5 offset:32768
    s_waitcnt lgkmcnt(9)
    s_nop 0
    v_mfma_f32_32x32x16_bf16 v[48:63], v[212:215], v[44:47], v[48:63]
    ds_read_b128 v[44:47], v5 offset:36864
    v_mfma_f32_32x32x16_bf16 v[64:79], v[212:215], v[16:19], v[64:79]
    v_mfma_f32_32x32x16_bf16 v[80:95], v[212:215], v[20:23], v[80:95]
    s_waitcnt lgkmcnt(5)
    s_nop 0
    v_mfma_f32_32x32x16_bf16 v[48:63], v[216:219], v[24:27], v[48:63]
    v_mfma_f32_32x32x16_bf16 v[64:79], v[216:219], v[28:31], v[64:79]
    s_waitcnt lgkmcnt(0)
    s_barrier
    v_mfma_f32_32x32x16_bf16 v[80:95], v[216:219], v[32:35], v[80:95]
    ds_read_b64_tr_b16 v[224:225], v11 offset:12288
    ds_read_b64_tr_b16 v[226:227], v11 offset:13312
    ds_read_b128 v[16:19], v6 offset:0
    v_mfma_f32_32x32x16_bf16 v[48:63], v[220:223], v[36:39], v[48:63]
    ds_read_b128 v[20:23], v6 offset:4096
    ds_read_b128 v[24:27], v6 offset:8192
    ds_read_b64_tr_b16 v[228:229], v11 offset:16384
    v_mfma_f32_32x32x16_bf16 v[64:79], v[220:223], v[40:43], v[64:79]
    ds_read_b64_tr_b16 v[230:231], v11 offset:17408
    ds_read_b128 v[28:31], v7 offset:0
    ds_read_b128 v[32:35], v7 offset:4096
    v_mfma_f32_32x32x16_bf16 v[80:95], v[220:223], v[44:47], v[80:95]
    ds_read_b128 v[36:39], v7 offset:8192
    ds_read_b64_tr_b16 v[232:233], v11 offset:20480
    ds_read_b64_tr_b16 v[234:235], v11 offset:21504
    s_waitcnt lgkmcnt(7)
    s_nop 0
    v_mfma_f32_32x32x16_bf16 v[48:63], v[224:227], v[16:19], v[48:63]
    ds_read_b128 v[40:43], v8 offset:0
    ds_read_b128 v[44:47], v8 offset:4096
    ds_read_b128 v[16:19], v8 offset:8192
    v_mfma_f32_32x32x16_bf16 v[64:79], v[224:227], v[20:23], v[64:79]
    ds_read_b64_tr_b16 v[236:237], v11 offset:24576
    ds_read_b64_tr_b16 v[238:239], v11 offset:25600
    ds_read_b128 v[20:23], v9 offset:0
    v_mfma_f32_32x32x16_bf16 v[80:95], v[224:227], v[24:27], v[80:95]
    ds_read_b128 v[24:27], v9 offset:4096
    s_waitcnt lgkmcnt(9)
    s_nop 0
    v_mfma_f32_32x32x16_bf16 v[48:63], v[228:231], v[28:31], v[48:63]
    ds_read_b128 v[28:31], v9 offset:8192
    v_mfma_f32_32x32x16_bf16 v[64:79], v[228:231], v[32:35], v[64:79]
    v_mfma_f32_32x32x16_bf16 v[80:95], v[228:231], v[36:39], v[80:95]
    s_waitcnt lgkmcnt(5)
    s_nop 0
    v_mfma_f32_32x32x16_bf16 v[48:63], v[232:235], v[40:43], v[48:63]
    v_mfma_f32_32x32x16_bf16 v[64:79], v[232:235], v[44:47], v[64:79]
    s_waitcnt lgkmcnt(0)
    s_barrier
    v_mfma_f32_32x32x16_bf16 v[80:95], v[232:235], v[16:19], v[80:95]
    ds_read_b64_tr_b16 v[240:241], v10 offset:12288
    ds_read_b64_tr_b16 v[242:243], v10 offset:13312
    ds_read_b128 v[32:35], v2 offset:0
    v_mfma_f32_32x32x16_bf16 v[48:63], v[236:239], v[20:23], v[48:63]
    ds_read_b128 v[36:39], v2 offset:4096
    ds_read_b128 v[40:43], v2 offset:8192
    ds_read_b64_tr_b16 v[244:245], v10 offset:16384
    v_mfma_f32_32x32x16_bf16 v[64:79], v[236:239], v[24:27], v[64:79]
    ds_read_b64_tr_b16 v[246:247], v10 offset:17408
    ds_read_b128 v[44:47], v3 offset:0
    ds_read_b128 v[16:19], v3 offset:4096
    v_mfma_f32_32x32x16_bf16 v[80:95], v[236:239], v[28:31], v[80:95]
    ds_read_b128 v[20:23], v3 offset:8192
    ds_read_b64_tr_b16 v[248:249], v10 offset:20480
    ds_read_b64_tr_b16 v[250:251], v10 offset:21504
    s_waitcnt lgkmcnt(7)
    s_nop 0
    v_mfma_f32_32x32x16_bf16 v[48:63], v[240:243], v[32:35], v[48:63]
    ds_read_b128 v[24:27], v4 offset:0
    ds_read_b128 v[28:31], v4 offset:4096
    ds_read_b128 v[32:35], v4 offset:8192
    v_mfma_f32_32x32x16_bf16 v[64:79], v[240:243], v[36:39], v[64:79]
    ds_read_b64_tr_b16 v[252:253], v10 offset:24576
    ds_read_b64_tr_b16 v[254:255], v10 offset:25600
    ds_read_b128 v[36:39], v5 offset:0
    v_mfma_f32_32x32x16_bf16 v[80:95], v[240:243], v[40:43], v[80:95]
    ds_read_b128 v[40:43], v5 offset:4096
    s_waitcnt lgkmcnt(9)
    s_nop 0
    v_mfma_f32_32x32x16_bf16 v[48:63], v[244:247], v[44:47], v[48:63]
    ds_read_b128 v[44:47], v5 offset:8192
    v_mfma_f32_32x32x16_bf16 v[64:79], v[244:247], v[16:19], v[64:79]
    v_mfma_f32_32x32x16_bf16 v[80:95], v[244:247], v[20:23], v[80:95]
    s_waitcnt lgkmcnt(5)
    s_nop 0
    v_mfma_f32_32x32x16_bf16 v[48:63], v[248:251], v[24:27], v[48:63]
    v_mfma_f32_32x32x16_bf16 v[64:79], v[248:251], v[28:31], v[64:79]
    s_barrier
    s_nop 0
    v_add_u32 v6, 86016, v2
    v_add_u32 v7, 86016, v3
    v_add_u32 v8, 86016, v4
    v_add_u32 v9, 86016, v5
    v_mfma_f32_32x32x16_bf16 v[80:95], v[248:251], v[32:35], v[80:95]
    ds_read_b128 v[16:19], v6 offset:0
    ds_read_b128 v[20:23], v7 offset:0
    ds_read_b128 v[24:27], v8 offset:0
    s_waitcnt lgkmcnt(3)
    s_nop 0
    v_mfma_f32_32x32x16_bf16 v[48:63], v[252:255], v[36:39], v[48:63]
    ds_read_b128 v[28:31], v9 offset:0
    v_mfma_f32_32x32x16_bf16 v[64:79], v[252:255], v[40:43], v[64:79]
    v_mfma_f32_32x32x16_bf16 v[80:95], v[252:255], v[44:47], v[80:95]
    s_waitcnt lgkmcnt(3)
    s_nop 0
    v_mfma_f32_32x32x16_bf16 v[32:47], v[96:99], v[16:19], 0
    ds_read_b128 v[96:99], v6 offset:4096
    s_waitcnt lgkmcnt(3)
    s_nop 0
    v_mfma_f32_32x32x16_bf16 v[32:47], v[100:103], v[20:23], v[32:47]
    ds_read_b128 v[100:103], v7 offset:4096
    s_waitcnt lgkmcnt(3)
    s_nop 0
    v_mfma_f32_32x32x16_bf16 v[32:47], v[104:107], v[24:27], v[32:47]
    ds_read_b128 v[104:107], v8 offset:4096
    s_waitcnt lgkmcnt(3)
    s_nop 0
    v_mfma_f32_32x32x16_bf16 v[32:47], v[108:111], v[28:31], v[32:47]
    ds_read_b128 v[108:111], v9 offset:4096
    ds_read_b128 v[16:19], v6 offset:8192
    v_mul_f32 v48, s28, v48
    v_mul_f32 v49, s28, v49
    v_mul_f32 v50, s28, v50
    v_mul_f32_e64 v51, s28, v51
    s_waitcnt lgkmcnt(4)
    v_mfma_f32_32x32x16_bf16 v[32:47], v[112:115], v[96:99], v[32:47]
    ds_read_b128 v[20:23], v7 offset:8192
    ds_read_b128 v[24:27], v8 offset:8192
    v_mul_f32 v52, s28, v52
    v_mul_f32 v53, s28, v53
    v_mul_f32 v54, s28, v54
    v_mul_f32_e64 v55, s28, v55
    s_waitcnt lgkmcnt(5)
    v_mfma_f32_32x32x16_bf16 v[32:47], v[116:119], v[100:103], v[32:47]
    ds_read_b128 v[28:31], v9 offset:8192
    ds_read_b128 v[96:99], v6 offset:12288
    v_cvt_pk_bf16_f32 v48, v48, v49
    v_cvt_pk_bf16_f32 v49, v50, v51
    v_cvt_pk_bf16_f32 v50, v52, v53
    v_cvt_pk_bf16_f32 v51, v54, v55
    s_waitcnt lgkmcnt(6)
    s_nop 0
    v_mfma_f32_32x32x16_bf16 v[32:47], v[120:123], v[104:107], v[32:47]
    ds_read_b128 v[100:103], v7 offset:12288
    ds_read_b128 v[104:107], v8 offset:12288
    buffer_store_dwordx4 v[48:51], v12, s[36:39], s34 offen offset:0 sc1
    v_mul_f32 v56, s28, v56
    v_mul_f32 v57, s28, v57
    v_mul_f32 v58, s28, v58
    s_waitcnt lgkmcnt(7)
    v_mfma_f32_32x32x16_bf16 v[32:47], v[124:127], v[108:111], v[32:47]
    ds_read_b128 v[108:111], v9 offset:12288
    v_mul_f32 v59, s28, v59
    v_mul_f32 v60, s28, v60
    v_mul_f32 v61, s28, v61
    v_mul_f32_e64 v62, s28, v62
    s_waitcnt lgkmcnt(6)
    v_mfma_f32_32x32x16_bf16 v[32:47], v[128:131], v[16:19], v[32:47]
    ds_read_b128 v[16:19], v6 offset:17408
    v_mul_f32_e64 v63, s28, v63
    v_cvt_pk_bf16_f32 v56, v56, v57
    v_cvt_pk_bf16_f32 v57, v58, v59
    v_cvt_pk_bf16_f32 v58, v60, v61
    v_mfma_f32_32x32x16_bf16 v[32:47], v[132:135], v[20:23], v[32:47]
    ds_read_b128 v[20:23], v7 offset:17408
    v_cvt_pk_bf16_f32 v59, v62, v63
    buffer_store_dwordx4 v[56:59], v13, s[36:39], s34 offen offset:0 sc1
    v_mul_f32 v64, s28, v64
    v_mul_f32_e64 v65, s28, v65
    s_waitcnt lgkmcnt(6)
    v_mfma_f32_32x32x16_bf16 v[32:47], v[136:139], v[24:27], v[32:47]
    ds_read_b128 v[24:27], v8 offset:17408
    v_mul_f32 v66, s28, v66
    v_mul_f32 v67, s28, v67
    v_mul_f32 v68, s28, v68
    v_mul_f32 v69, s28, v69
    v_mfma_f32_32x32x16_bf16 v[32:47], v[140:143], v[28:31], v[32:47]
    ds_read_b128 v[28:31], v9 offset:17408
    v_mul_f32 v70, s28, v70
    v_mul_f32 v71, s28, v71
    v_cvt_pk_bf16_f32 v64, v64, v65
    v_cvt_pk_bf16_f32 v65, v66, v67
    s_barrier
    s_waitcnt lgkmcnt(6)
    v_mfma_f32_32x32x16_bf16 v[32:47], v[144:147], v[96:99], v[32:47]
    ds_read_b128 v[96:99], v6 offset:21504
    v_cvt_pk_bf16_f32 v66, v68, v69
    v_cvt_pk_bf16_f32 v67, v70, v71
    buffer_store_dwordx4 v[64:67], v12, s[36:39], s34 offen offset:2560 sc1
    v_mul_f32_e64 v72, s28, v72
    v_mfma_f32_32x32x16_bf16 v[32:47], v[148:151], v[100:103], v[32:47]
    ds_read_b128 v[100:103], v7 offset:21504
    v_mul_f32 v73, s28, v73
    v_mul_f32 v74, s28, v74
    v_mul_f32 v75, s28, v75
    v_mul_f32_e64 v76, s28, v76
    s_waitcnt lgkmcnt(6)
    v_mfma_f32_32x32x16_bf16 v[32:47], v[152:155], v[104:107], v[32:47]
    ds_read_b128 v[104:107], v8 offset:21504
    v_mul_f32 v77, s28, v77
    v_mul_f32 v78, s28, v78
    v_mul_f32_e64 v79, s28, v79
    v_cvt_pk_bf16_f32 v72, v72, v73
    v_mfma_f32_32x32x16_bf16 v[32:47], v[156:159], v[108:111], v[32:47]
    ds_read_b128 v[108:111], v9 offset:21504
    v_cvt_pk_bf16_f32 v73, v74, v75
    v_cvt_pk_bf16_f32 v74, v76, v77
    v_cvt_pk_bf16_f32 v75, v78, v79
    buffer_store_dwordx4 v[72:75], v13, s[36:39], s34 offen offset:2560 sc1
    s_waitcnt lgkmcnt(6)
    s_nop 0
    v_mfma_f32_32x32x16_bf16 v[32:47], v[160:163], v[16:19], v[32:47]
    ds_read_b128 v[16:19], v6 offset:25600
    v_mul_f32 v80, s28, v80
    v_mul_f32 v81, s28, v81
    v_mul_f32 v82, s28, v82
    v_mul_f32 v83, s28, v83
    v_mfma_f32_32x32x16_bf16 v[32:47], v[164:167], v[20:23], v[32:47]
    ds_read_b128 v[20:23], v7 offset:25600
    v_mul_f32 v84, s28, v84
    v_mul_f32 v85, s28, v85
    v_mul_f32 v86, s28, v86
    v_mul_f32_e64 v87, s28, v87
    s_waitcnt lgkmcnt(6)
    v_mfma_f32_32x32x16_bf16 v[32:47], v[168:171], v[24:27], v[32:47]
    ds_read_b128 v[24:27], v8 offset:25600
    v_cvt_pk_bf16_f32 v80, v80, v81
    v_cvt_pk_bf16_f32 v81, v82, v83
    v_cvt_pk_bf16_f32 v82, v84, v85
    v_cvt_pk_bf16_f32 v83, v86, v87
    v_mfma_f32_32x32x16_bf16 v[32:47], v[172:175], v[28:31], v[32:47]
    ds_read_b128 v[28:31], v9 offset:25600
    buffer_store_dwordx4 v[80:83], v12, s[36:39], s35 offen offset:0 sc1
    v_mul_f32 v88, s28, v88
    v_mul_f32 v89, s28, v89
    v_mul_f32 v90, s28, v90
    s_waitcnt lgkmcnt(6)
    v_mfma_f32_32x32x16_bf16 v[32:47], v[176:179], v[96:99], v[32:47]
    ds_read_b128 v[96:99], v6 offset:29696
    v_mul_f32 v91, s28, v91
    v_mul_f32 v92, s28, v92
    v_mul_f32 v93, s28, v93
    v_mul_f32 v94, s28, v94
    v_mfma_f32_32x32x16_bf16 v[32:47], v[180:183], v[100:103], v[32:47]
    ds_read_b128 v[100:103], v7 offset:29696
    v_mul_f32_e64 v95, s28, v95
    v_cvt_pk_bf16_f32 v88, v88, v89
    v_cvt_pk_bf16_f32 v89, v90, v91
    v_cvt_pk_bf16_f32 v90, v92, v93
    s_waitcnt lgkmcnt(6)
    s_nop 0
    v_mfma_f32_32x32x16_bf16 v[32:47], v[184:187], v[104:107], v[32:47]
    ds_read_b128 v[104:107], v8 offset:29696
    v_cvt_pk_bf16_f32 v91, v94, v95
    buffer_store_dwordx4 v[88:91], v13, s[36:39], s35 offen offset:0 sc1
    v_mfma_f32_32x32x16_bf16 v[32:47], v[188:191], v[108:111], v[32:47]
    ds_read_b128 v[108:111], v9 offset:29696
    s_waitcnt lgkmcnt(6)
    s_nop 0
    v_mfma_f32_32x32x16_bf16 v[32:47], v[192:195], v[16:19], v[32:47]
    ds_read_b128 v[16:19], v6 offset:33792
    v_mfma_f32_32x32x16_bf16 v[32:47], v[196:199], v[20:23], v[32:47]
    ds_read_b128 v[20:23], v7 offset:33792
    s_waitcnt lgkmcnt(6)
    s_nop 0
    v_mfma_f32_32x32x16_bf16 v[32:47], v[200:203], v[24:27], v[32:47]
    ds_read_b128 v[24:27], v8 offset:33792
    v_mfma_f32_32x32x16_bf16 v[32:47], v[204:207], v[28:31], v[32:47]
    ds_read_b128 v[28:31], v9 offset:33792
    s_waitcnt lgkmcnt(6)
    s_nop 0
    v_mfma_f32_32x32x16_bf16 v[32:47], v[208:211], v[96:99], v[32:47]
    ds_read_b128 v[96:99], v6 offset:37888
    v_mfma_f32_32x32x16_bf16 v[32:47], v[212:215], v[100:103], v[32:47]
    ds_read_b128 v[100:103], v7 offset:37888
    s_waitcnt lgkmcnt(6)
    s_nop 0
    v_mfma_f32_32x32x16_bf16 v[32:47], v[216:219], v[104:107], v[32:47]
    ds_read_b128 v[104:107], v8 offset:37888
    v_mov_b32_e64 v3, 0
    buffer_load_dword v2, v3, s[48:51], 0 offen sc1
    v_mfma_f32_32x32x16_bf16 v[32:47], v[220:223], v[108:111], v[32:47]
    ds_read_b128 v[108:111], v9 offset:37888
    s_waitcnt lgkmcnt(6)
    s_nop 0
    v_mfma_f32_32x32x16_bf16 v[32:47], v[224:227], v[16:19], v[32:47]
    v_mfma_f32_32x32x16_bf16 v[32:47], v[228:231], v[20:23], v[32:47]
    s_waitcnt lgkmcnt(4)
    s_nop 0
    v_mfma_f32_32x32x16_bf16 v[32:47], v[232:235], v[24:27], v[32:47]
    v_mfma_f32_32x32x16_bf16 v[32:47], v[236:239], v[28:31], v[32:47]
    s_waitcnt lgkmcnt(2)
    s_nop 0
    v_mfma_f32_32x32x16_bf16 v[32:47], v[240:243], v[96:99], v[32:47]
    v_mfma_f32_32x32x16_bf16 v[32:47], v[244:247], v[100:103], v[32:47]
    s_waitcnt lgkmcnt(0)
    s_nop 0
    v_mfma_f32_32x32x16_bf16 v[32:47], v[248:251], v[104:107], v[32:47]
    v_mfma_f32_32x32x16_bf16 v[32:47], v[252:255], v[108:111], v[32:47]
    s_nop 7
    s_nop 3
    v_pk_mul_f32 v[32:33], v[32:33], s[28:29]
    v_pk_mul_f32 v[34:35], v[34:35], s[28:29]
    v_pk_mul_f32 v[36:37], v[36:37], s[28:29]
    v_pk_mul_f32 v[38:39], v[38:39], s[28:29]
    v_cvt_pk_bf16_f32 v32, v32, v33
    v_cvt_pk_bf16_f32 v33, v34, v35
    v_cvt_pk_bf16_f32 v34, v36, v37
    v_cvt_pk_bf16_f32 v35, v38, v39
    buffer_store_dwordx4 v[32:35], v12, s[36:39], s35 offen offset:2560 sc1
    v_pk_mul_f32 v[40:41], v[40:41], s[28:29]
    v_pk_mul_f32 v[42:43], v[42:43], s[28:29]
    v_pk_mul_f32 v[44:45], v[44:45], s[28:29]
    v_pk_mul_f32 v[46:47], v[46:47], s[28:29]
    v_cvt_pk_bf16_f32 v40, v40, v41
    v_cvt_pk_bf16_f32 v41, v42, v43
    v_cvt_pk_bf16_f32 v42, v44, v45
    v_cvt_pk_bf16_f32 v43, v46, v47
    buffer_store_dwordx4 v[40:43], v13, s[36:39], s35 offen offset:2560 sc1
    s_branch C_sig1
.p2align 3
C_gemmV:
    s_barrier
    s_nop 0
    ds_read_b64_tr_b16 v[96:97], v10 offset:12288
    ds_read_b64_tr_b16 v[98:99], v10 offset:13312
    ds_read_b128 v[16:19], v2 offset:0
    ds_read_b128 v[20:23], v2 offset:4096
    ds_read_b128 v[24:27], v2 offset:8192
    s_waitcnt lgkmcnt(2)
    s_nop 0
    v_mfma_f32_32x32x16_bf16 v[48:63], v[16:19], v[96:99], 0
    ds_read_b64_tr_b16 v[100:101], v10 offset:16384
    ds_read_b64_tr_b16 v[102:103], v10 offset:17408
    ds_read_b128 v[28:31], v3 offset:0
    s_waitcnt lgkmcnt(4)
    s_nop 0
    v_mfma_f32_32x32x16_bf16 v[64:79], v[20:23], v[96:99], 0
    ds_read_b128 v[32:35], v3 offset:4096
    ds_read_b128 v[36:39], v3 offset:8192
    ds_read_b64_tr_b16 v[104:105], v10 offset:20480
    s_waitcnt lgkmcnt(6)
    s_nop 0
    v_mfma_f32_32x32x16_bf16 v[80:95], v[24:27], v[96:99], 0
    ds_read_b64_tr_b16 v[106:107], v10 offset:21504
    ds_read_b128 v[40:43], v4 offset:0
    ds_read_b128 v[44:47], v4 offset:4096
    s_waitcnt lgkmcnt(4)
    s_nop 0
    v_mfma_f32_32x32x16_bf16 v[48:63], v[28:31], v[100:103], v[48:63]
    ds_read_b128 v[16:19], v4 offset:8192
    ds_read_b64_tr_b16 v[108:109], v10 offset:24576
    ds_read_b64_tr_b16 v[110:111], v10 offset:25600
    v_mfma_f32_32x32x16_bf16 v[64:79], v[32:35], v[100:103], v[64:79]
    ds_read_b128 v[20:23], v5 offset:0
    ds_read_b128 v[24:27], v5 offset:4096
    ds_read_b128 v[28:31], v5 offset:8192
    v_mfma_f32_32x32x16_bf16 v[80:95], v[36:39], v[100:103], v[80:95]
    s_waitcnt lgkmcnt(5)
    s_nop 0
    v_mfma_f32_32x32x16_bf16 v[48:63], v[40:43], v[104:107], v[48:63]
    v_mfma_f32_32x32x16_bf16 v[64:79], v[44:47], v[104:107], v[64:79]
    s_waitcnt lgkmcnt(0)
    s_barrier
    v_mfma_f32_32x32x16_bf16 v[80:95], v[16:19], v[104:107], v[80:95]
    ds_read_b64_tr_b16 v[112:113], v10 offset:40960
    ds_read_b64_tr_b16 v[114:115], v10 offset:41984
    ds_read_b128 v[32:35], v2 offset:28672
    v_mfma_f32_32x32x16_bf16 v[48:63], v[20:23], v[108:111], v[48:63]
    ds_read_b128 v[36:39], v2 offset:32768
    ds_read_b128 v[40:43], v2 offset:36864
    ds_read_b64_tr_b16 v[116:117], v10 offset:45056
    v_mfma_f32_32x32x16_bf16 v[64:79], v[24:27], v[108:111], v[64:79]
    ds_read_b64_tr_b16 v[118:119], v10 offset:46080
    ds_read_b128 v[44:47], v3 offset:28672
    ds_read_b128 v[16:19], v3 offset:32768
    v_mfma_f32_32x32x16_bf16 v[80:95], v[28:31], v[108:111], v[80:95]
    ds_read_b128 v[20:23], v3 offset:36864
    ds_read_b64_tr_b16 v[120:121], v10 offset:49152
    ds_read_b64_tr_b16 v[122:123], v10 offset:50176
    s_waitcnt lgkmcnt(7)
    s_nop 0
    v_mfma_f32_32x32x16_bf16 v[48:63], v[32:35], v[112:115], v[48:63]
    ds_read_b128 v[24:27], v4 offset:28672
    ds_read_b128 v[28:31], v4 offset:32768
    ds_read_b128 v[32:35], v4 offset:36864
    v_mfma_f32_32x32x16_bf16 v[64:79], v[36:39], v[112:115], v[64:79]
    ds_read_b64_tr_b16 v[124:125], v10 offset:53248
    ds_read_b64_tr_b16 v[126:127], v10 offset:54272
    ds_read_b128 v[36:39], v5 offset:28672
    v_mfma_f32_32x32x16_bf16 v[80:95], v[40:43], v[112:115], v[80:95]
    ds_read_b128 v[40:43], v5 offset:32768
    s_waitcnt lgkmcnt(9)
    s_nop 0
    v_mfma_f32_32x32x16_bf16 v[48:63], v[44:47], v[116:119], v[48:63]
    ds_read_b128 v[44:47], v5 offset:36864
    v_mfma_f32_32x32x16_bf16 v[64:79], v[16:19], v[116:119], v[64:79]
    v_mfma_f32_32x32x16_bf16 v[80:95], v[20:23], v[116:119], v[80:95]
    s_waitcnt lgkmcnt(5)
    s_nop 0
    v_mfma_f32_32x32x16_bf16 v[48:63], v[24:27], v[120:123], v[48:63]
    v_mfma_f32_32x32x16_bf16 v[64:79], v[28:31], v[120:123], v[64:79]
    s_waitcnt lgkmcnt(0)
    s_barrier
    v_mfma_f32_32x32x16_bf16 v[80:95], v[32:35], v[120:123], v[80:95]
    ds_read_b64_tr_b16 v[128:129], v11 offset:12288
    ds_read_b64_tr_b16 v[130:131], v11 offset:13312
    ds_read_b128 v[16:19], v6 offset:0
    v_mfma_f32_32x32x16_bf16 v[48:63], v[36:39], v[124:127], v[48:63]
    ds_read_b128 v[20:23], v6 offset:4096
    ds_read_b128 v[24:27], v6 offset:8192
    ds_read_b64_tr_b16 v[132:133], v11 offset:16384
    v_mfma_f32_32x32x16_bf16 v[64:79], v[40:43], v[124:127], v[64:79]
    ds_read_b64_tr_b16 v[134:135], v11 offset:17408
    ds_read_b128 v[28:31], v7 offset:0
    ds_read_b128 v[32:35], v7 offset:4096
    v_mfma_f32_32x32x16_bf16 v[80:95], v[44:47], v[124:127], v[80:95]
    ds_read_b128 v[36:39], v7 offset:8192
    ds_read_b64_tr_b16 v[136:137], v11 offset:20480
    ds_read_b64_tr_b16 v[138:139], v11 offset:21504
    s_waitcnt lgkmcnt(7)
    s_nop 0
    v_mfma_f32_32x32x16_bf16 v[48:63], v[16:19], v[128:131], v[48:63]
    ds_read_b128 v[40:43], v8 offset:0
    ds_read_b128 v[44:47], v8 offset:4096
    ds_read_b128 v[16:19], v8 offset:8192
    v_mfma_f32_32x32x16_bf16 v[64:79], v[20:23], v[128:131], v[64:79]
    ds_read_b64_tr_b16 v[140:141], v11 offset:24576
    ds_read_b64_tr_b16 v[142:143], v11 offset:25600
    ds_read_b128 v[20:23], v9 offset:0
    v_mfma_f32_32x32x16_bf16 v[80:95], v[24:27], v[128:131], v[80:95]
    ds_read_b128 v[24:27], v9 offset:4096
    s_waitcnt lgkmcnt(9)
    s_nop 0
    v_mfma_f32_32x32x16_bf16 v[48:63], v[28:31], v[132:135], v[48:63]
    ds_read_b128 v[28:31], v9 offset:8192
    v_mfma_f32_32x32x16_bf16 v[64:79], v[32:35], v[132:135], v[64:79]
    v_mfma_f32_32x32x16_bf16 v[80:95], v[36:39], v[132:135], v[80:95]
    s_waitcnt lgkmcnt(5)
    s_nop 0
    v_mfma_f32_32x32x16_bf16 v[48:63], v[40:43], v[136:139], v[48:63]
    v_mfma_f32_32x32x16_bf16 v[64:79], v[44:47], v[136:139], v[64:79]
    s_waitcnt lgkmcnt(0)
    s_barrier
    v_mfma_f32_32x32x16_bf16 v[80:95], v[16:19], v[136:139], v[80:95]
    ds_read_b64_tr_b16 v[144:145], v10 offset:12288
    ds_read_b64_tr_b16 v[146:147], v10 offset:13312
    ds_read_b128 v[32:35], v2 offset:0
    v_mfma_f32_32x32x16_bf16 v[48:63], v[20:23], v[140:143], v[48:63]
    ds_read_b128 v[36:39], v2 offset:4096
    ds_read_b128 v[40:43], v2 offset:8192
    ds_read_b64_tr_b16 v[148:149], v10 offset:16384
    v_mfma_f32_32x32x16_bf16 v[64:79], v[24:27], v[140:143], v[64:79]
    ds_read_b64_tr_b16 v[150:151], v10 offset:17408
    ds_read_b128 v[44:47], v3 offset:0
    ds_read_b128 v[16:19], v3 offset:4096
    v_mfma_f32_32x32x16_bf16 v[80:95], v[28:31], v[140:143], v[80:95]
    ds_read_b128 v[20:23], v3 offset:8192
    ds_read_b64_tr_b16 v[152:153], v10 offset:20480
    ds_read_b64_tr_b16 v[154:155], v10 offset:21504
    s_waitcnt lgkmcnt(7)
    s_nop 0
    v_mfma_f32_32x32x16_bf16 v[48:63], v[32:35], v[144:147], v[48:63]
    ds_read_b128 v[24:27], v4 offset:0
    ds_read_b128 v[28:31], v4 offset:4096
    ds_read_b128 v[32:35], v4 offset:8192
    v_mfma_f32_32x32x16_bf16 v[64:79], v[36:39], v[144:147], v[64:79]
    ds_read_b64_tr_b16 v[156:157], v10 offset:24576
    ds_read_b64_tr_b16 v[158:159], v10 offset:25600
    ds_read_b128 v[36:39], v5 offset:0
    v_mfma_f32_32x32x16_bf16 v[80:95], v[40:43], v[144:147], v[80:95]
    ds_read_b128 v[40:43], v5 offset:4096
    s_waitcnt lgkmcnt(9)
    s_nop 0
    v_mfma_f32_32x32x16_bf16 v[48:63], v[44:47], v[148:151], v[48:63]
    ds_read_b128 v[44:47], v5 offset:8192
    v_mfma_f32_32x32x16_bf16 v[64:79], v[16:19], v[148:151], v[64:79]
    v_mfma_f32_32x32x16_bf16 v[80:95], v[20:23], v[148:151], v[80:95]
    s_waitcnt lgkmcnt(5)
    s_nop 0
    v_mfma_f32_32x32x16_bf16 v[48:63], v[24:27], v[152:155], v[48:63]
    v_mfma_f32_32x32x16_bf16 v[64:79], v[28:31], v[152:155], v[64:79]
    s_waitcnt lgkmcnt(0)
    s_barrier
    v_mfma_f32_32x32x16_bf16 v[80:95], v[32:35], v[152:155], v[80:95]
    ds_read_b64_tr_b16 v[160:161], v10 offset:40960
    ds_read_b64_tr_b16 v[162:163], v10 offset:41984
    ds_read_b128 v[16:19], v2 offset:28672
    v_mfma_f32_32x32x16_bf16 v[48:63], v[36:39], v[156:159], v[48:63]
    ds_read_b128 v[20:23], v2 offset:32768
    ds_read_b128 v[24:27], v2 offset:36864
    ds_read_b64_tr_b16 v[164:165], v10 offset:45056
    v_mfma_f32_32x32x16_bf16 v[64:79], v[40:43], v[156:159], v[64:79]
    ds_read_b64_tr_b16 v[166:167], v10 offset:46080
    ds_read_b128 v[28:31], v3 offset:28672
    ds_read_b128 v[32:35], v3 offset:32768
    v_mfma_f32_32x32x16_bf16 v[80:95], v[44:47], v[156:159], v[80:95]
    ds_read_b128 v[36:39], v3 offset:36864
    ds_read_b64_tr_b16 v[168:169], v10 offset:49152
    ds_read_b64_tr_b16 v[170:171], v10 offset:50176
    s_waitcnt lgkmcnt(7)
    s_nop 0
    v_mfma_f32_32x32x16_bf16 v[48:63], v[16:19], v[160:163], v[48:63]
    ds_read_b128 v[40:43], v4 offset:28672
    ds_read_b128 v[44:47], v4 offset:32768
    ds_read_b128 v[16:19], v4 offset:36864
    v_mfma_f32_32x32x16_bf16 v[64:79], v[20:23], v[160:163], v[64:79]
    ds_read_b64_tr_b16 v[172:173], v10 offset:53248
    ds_read_b64_tr_b16 v[174:175], v10 offset:54272
    ds_read_b128 v[20:23], v5 offset:28672
    v_mfma_f32_32x32x16_bf16 v[80:95], v[24:27], v[160:163], v[80:95]
    ds_read_b128 v[24:27], v5 offset:32768
    s_waitcnt lgkmcnt(9)
    s_nop 0
    v_mfma_f32_32x32x16_bf16 v[48:63], v[28:31], v[164:167], v[48:63]
    ds_read_b128 v[28:31], v5 offset:36864
    v_mfma_f32_32x32x16_bf16 v[64:79], v[32:35], v[164:167], v[64:79]
    v_mfma_f32_32x32x16_bf16 v[80:95], v[36:39], v[164:167], v[80:95]
    s_waitcnt lgkmcnt(5)
    s_nop 0
    v_mfma_f32_32x32x16_bf16 v[48:63], v[40:43], v[168:171], v[48:63]
    v_mfma_f32_32x32x16_bf16 v[64:79], v[44:47], v[168:171], v[64:79]
    s_waitcnt lgkmcnt(0)
    s_barrier
    v_mfma_f32_32x32x16_bf16 v[80:95], v[16:19], v[168:171], v[80:95]
    ds_read_b64_tr_b16 v[176:177], v11 offset:12288
    ds_read_b64_tr_b16 v[178:179], v11 offset:13312
    ds_read_b128 v[32:35], v6 offset:0
    v_mfma_f32_32x32x16_bf16 v[48:63], v[20:23], v[172:175], v[48:63]
    ds_read_b128 v[36:39], v6 offset:4096
    ds_read_b128 v[40:43], v6 offset:8192
    ds_read_b64_tr_b16 v[180:181], v11 offset:16384
    v_mfma_f32_32x32x16_bf16 v[64:79], v[24:27], v[172:175], v[64:79]
    ds_read_b64_tr_b16 v[182:183], v11 offset:17408
    ds_read_b128 v[44:47], v7 offset:0
    ds_read_b128 v[16:19], v7 offset:4096
    v_mfma_f32_32x32x16_bf16 v[80:95], v[28:31], v[172:175], v[80:95]
    ds_read_b128 v[20:23], v7 offset:8192
    ds_read_b64_tr_b16 v[184:185], v11 offset:20480
    ds_read_b64_tr_b16 v[186:187], v11 offset:21504
    s_waitcnt lgkmcnt(7)
    s_nop 0
    v_mfma_f32_32x32x16_bf16 v[48:63], v[32:35], v[176:179], v[48:63]
    ds_read_b128 v[24:27], v8 offset:0
    ds_read_b128 v[28:31], v8 offset:4096
    ds_read_b128 v[32:35], v8 offset:8192
    v_mfma_f32_32x32x16_bf16 v[64:79], v[36:39], v[176:179], v[64:79]
    ds_read_b64_tr_b16 v[188:189], v11 offset:24576
    ds_read_b64_tr_b16 v[190:191], v11 offset:25600
    ds_read_b128 v[36:39], v9 offset:0
    v_mfma_f32_32x32x16_bf16 v[80:95], v[40:43], v[176:179], v[80:95]
    ds_read_b128 v[40:43], v9 offset:4096
    s_waitcnt lgkmcnt(9)
    s_nop 0
    v_mfma_f32_32x32x16_bf16 v[48:63], v[44:47], v[180:183], v[48:63]
    ds_read_b128 v[44:47], v9 offset:8192
    v_mfma_f32_32x32x16_bf16 v[64:79], v[16:19], v[180:183], v[64:79]
    v_mfma_f32_32x32x16_bf16 v[80:95], v[20:23], v[180:183], v[80:95]
    s_waitcnt lgkmcnt(5)
    s_nop 0
    v_mfma_f32_32x32x16_bf16 v[48:63], v[24:27], v[184:187], v[48:63]
    v_mfma_f32_32x32x16_bf16 v[64:79], v[28:31], v[184:187], v[64:79]
    s_waitcnt lgkmcnt(0)
    s_barrier
    v_mfma_f32_32x32x16_bf16 v[80:95], v[32:35], v[184:187], v[80:95]
    ds_read_b64_tr_b16 v[192:193], v10 offset:12288
    ds_read_b64_tr_b16 v[194:195], v10 offset:13312
    ds_read_b128 v[16:19], v2 offset:0
    v_mfma_f32_32x32x16_bf16 v[48:63], v[36:39], v[188:191], v[48:63]
    ds_read_b128 v[20:23], v2 offset:4096
    ds_read_b128 v[24:27], v2 offset:8192
    ds_read_b64_tr_b16 v[196:197], v10 offset:16384
    v_mfma_f32_32x32x16_bf16 v[64:79], v[40:43], v[188:191], v[64:79]
    ds_read_b64_tr_b16 v[198:199], v10 offset:17408
    ds_read_b128 v[28:31], v3 offset:0
    ds_read_b128 v[32:35], v3 offset:4096
    v_mfma_f32_32x32x16_bf16 v[80:95], v[44:47], v[188:191], v[80:95]
    ds_read_b128 v[36:39], v3 offset:8192
    ds_read_b64_tr_b16 v[200:201], v10 offset:20480
    ds_read_b64_tr_b16 v[202:203], v10 offset:21504
    s_waitcnt lgkmcnt(7)
    s_nop 0
    v_mfma_f32_32x32x16_bf16 v[48:63], v[16:19], v[192:195], v[48:63]
    ds_read_b128 v[40:43], v4 offset:0
    ds_read_b128 v[44:47], v4 offset:4096
    ds_read_b128 v[16:19], v4 offset:8192
    v_mfma_f32_32x32x16_bf16 v[64:79], v[20:23], v[192:195], v[64:79]
    ds_read_b64_tr_b16 v[204:205], v10 offset:24576
    ds_read_b64_tr_b16 v[206:207], v10 offset:25600
    ds_read_b128 v[20:23], v5 offset:0
    v_mfma_f32_32x32x16_bf16 v[80:95], v[24:27], v[192:195], v[80:95]
    ds_read_b128 v[24:27], v5 offset:4096
    s_waitcnt lgkmcnt(9)
    s_nop 0
    v_mfma_f32_32x32x16_bf16 v[48:63], v[28:31], v[196:199], v[48:63]
    ds_read_b128 v[28:31], v5 offset:8192
    v_mfma_f32_32x32x16_bf16 v[64:79], v[32:35], v[196:199], v[64:79]
    v_mfma_f32_32x32x16_bf16 v[80:95], v[36:39], v[196:199], v[80:95]
    s_waitcnt lgkmcnt(5)
    s_nop 0
    v_mfma_f32_32x32x16_bf16 v[48:63], v[40:43], v[200:203], v[48:63]
    v_mfma_f32_32x32x16_bf16 v[64:79], v[44:47], v[200:203], v[64:79]
    s_waitcnt lgkmcnt(0)
    s_barrier
    v_mfma_f32_32x32x16_bf16 v[80:95], v[16:19], v[200:203], v[80:95]
    ds_read_b64_tr_b16 v[208:209], v10 offset:40960
    ds_read_b64_tr_b16 v[210:211], v10 offset:41984
    ds_read_b128 v[32:35], v2 offset:28672
    v_mfma_f32_32x32x16_bf16 v[48:63], v[20:23], v[204:207], v[48:63]
    ds_read_b128 v[36:39], v2 offset:32768
    ds_read_b128 v[40:43], v2 offset:36864
    ds_read_b64_tr_b16 v[212:213], v10 offset:45056
    v_mfma_f32_32x32x16_bf16 v[64:79], v[24:27], v[204:207], v[64:79]
    ds_read_b64_tr_b16 v[214:215], v10 offset:46080
    ds_read_b128 v[44:47], v3 offset:28672
    ds_read_b128 v[16:19], v3 offset:32768
    v_mfma_f32_32x32x16_bf16 v[80:95], v[28:31], v[204:207], v[80:95]
    ds_read_b128 v[20:23], v3 offset:36864
    ds_read_b64_tr_b16 v[216:217], v10 offset:49152
    ds_read_b64_tr_b16 v[218:219], v10 offset:50176
    s_waitcnt lgkmcnt(7)
    s_nop 0
    v_mfma_f32_32x32x16_bf16 v[48:63], v[32:35], v[208:211], v[48:63]
    ds_read_b128 v[24:27], v4 offset:28672
    ds_read_b128 v[28:31], v4 offset:32768
    ds_read_b128 v[32:35], v4 offset:36864
    v_mfma_f32_32x32x16_bf16 v[64:79], v[36:39], v[208:211], v[64:79]
    ds_read_b64_tr_b16 v[220:221], v10 offset:53248
    ds_read_b64_tr_b16 v[222:223], v10 offset:54272
    ds_read_b128 v[36:39], v5 offset:28672
    v_mfma_f32_32x32x16_bf16 v[80:95], v[40:43], v[208:211], v[80:95]
    ds_read_b128 v[40:43], v5 offset:32768
    s_waitcnt lgkmcnt(9)
    s_nop 0
    v_mfma_f32_32x32x16_bf16 v[48:63], v[44:47], v[212:215], v[48:63]
    ds_read_b128 v[44:47], v5 offset:36864
    v_mfma_f32_32x32x16_bf16 v[64:79], v[16:19], v[212:215], v[64:79]
    v_mfma_f32_32x32x16_bf16 v[80:95], v[20:23], v[212:215], v[80:95]
    s_waitcnt lgkmcnt(5)
    s_nop 0
    v_mfma_f32_32x32x16_bf16 v[48:63], v[24:27], v[216:219], v[48:63]
    v_mfma_f32_32x32x16_bf16 v[64:79], v[28:31], v[216:219], v[64:79]
    s_waitcnt lgkmcnt(0)
    s_barrier
    v_mfma_f32_32x32x16_bf16 v[80:95], v[32:35], v[216:219], v[80:95]
    ds_read_b64_tr_b16 v[224:225], v11 offset:12288
    ds_read_b64_tr_b16 v[226:227], v11 offset:13312
    ds_read_b128 v[16:19], v6 offset:0
    v_mfma_f32_32x32x16_bf16 v[48:63], v[36:39], v[220:223], v[48:63]
    ds_read_b128 v[20:23], v6 offset:4096
    ds_read_b128 v[24:27], v6 offset:8192
    ds_read_b64_tr_b16 v[228:229], v11 offset:16384
    v_mfma_f32_32x32x16_bf16 v[64:79], v[40:43], v[220:223], v[64:79]
    ds_read_b64_tr_b16 v[230:231], v11 offset:17408
    ds_read_b128 v[28:31], v7 offset:0
    ds_read_b128 v[32:35], v7 offset:4096
    v_mfma_f32_32x32x16_bf16 v[80:95], v[44:47], v[220:223], v[80:95]
    ds_read_b128 v[36:39], v7 offset:8192
    ds_read_b64_tr_b16 v[232:233], v11 offset:20480
    ds_read_b64_tr_b16 v[234:235], v11 offset:21504
    s_waitcnt lgkmcnt(7)
    s_nop 0
    v_mfma_f32_32x32x16_bf16 v[48:63], v[16:19], v[224:227], v[48:63]
    ds_read_b128 v[40:43], v8 offset:0
    ds_read_b128 v[44:47], v8 offset:4096
    ds_read_b128 v[16:19], v8 offset:8192
    v_mfma_f32_32x32x16_bf16 v[64:79], v[20:23], v[224:227], v[64:79]
    ds_read_b64_tr_b16 v[236:237], v11 offset:24576
    ds_read_b64_tr_b16 v[238:239], v11 offset:25600
    ds_read_b128 v[20:23], v9 offset:0
    v_mfma_f32_32x32x16_bf16 v[80:95], v[24:27], v[224:227], v[80:95]
    ds_read_b128 v[24:27], v9 offset:4096
    s_waitcnt lgkmcnt(9)
    s_nop 0
    v_mfma_f32_32x32x16_bf16 v[48:63], v[28:31], v[228:231], v[48:63]
    ds_read_b128 v[28:31], v9 offset:8192
    v_mfma_f32_32x32x16_bf16 v[64:79], v[32:35], v[228:231], v[64:79]
    v_mfma_f32_32x32x16_bf16 v[80:95], v[36:39], v[228:231], v[80:95]
    s_waitcnt lgkmcnt(5)
    s_nop 0
    v_mfma_f32_32x32x16_bf16 v[48:63], v[40:43], v[232:235], v[48:63]
    v_mfma_f32_32x32x16_bf16 v[64:79], v[44:47], v[232:235], v[64:79]
    s_waitcnt lgkmcnt(0)
    s_barrier
    v_mfma_f32_32x32x16_bf16 v[80:95], v[16:19], v[232:235], v[80:95]
    ds_read_b64_tr_b16 v[240:241], v10 offset:12288
    ds_read_b64_tr_b16 v[242:243], v10 offset:13312
    ds_read_b128 v[32:35], v2 offset:0
    v_mfma_f32_32x32x16_bf16 v[48:63], v[20:23], v[236:239], v[48:63]
    ds_read_b128 v[36:39], v2 offset:4096
    ds_read_b128 v[40:43], v2 offset:8192
    ds_read_b64_tr_b16 v[244:245], v10 offset:16384
    v_mfma_f32_32x32x16_bf16 v[64:79], v[24:27], v[236:239], v[64:79]
    ds_read_b64_tr_b16 v[246:247], v10 offset:17408
    ds_read_b128 v[44:47], v3 offset:0
    ds_read_b128 v[16:19], v3 offset:4096
    v_mfma_f32_32x32x16_bf16 v[80:95], v[28:31], v[236:239], v[80:95]
    ds_read_b128 v[20:23], v3 offset:8192
    ds_read_b64_tr_b16 v[248:249], v10 offset:20480
    ds_read_b64_tr_b16 v[250:251], v10 offset:21504
    s_waitcnt lgkmcnt(7)
    s_nop 0
    v_mfma_f32_32x32x16_bf16 v[48:63], v[32:35], v[240:243], v[48:63]
    ds_read_b128 v[24:27], v4 offset:0
    ds_read_b128 v[28:31], v4 offset:4096
    ds_read_b128 v[32:35], v4 offset:8192
    v_mfma_f32_32x32x16_bf16 v[64:79], v[36:39], v[240:243], v[64:79]
    ds_read_b64_tr_b16 v[252:253], v10 offset:24576
    ds_read_b64_tr_b16 v[254:255], v10 offset:25600
    ds_read_b128 v[36:39], v5 offset:0
    v_mfma_f32_32x32x16_bf16 v[80:95], v[40:43], v[240:243], v[80:95]
    ds_read_b128 v[40:43], v5 offset:4096
    s_waitcnt lgkmcnt(9)
    s_nop 0
    v_mfma_f32_32x32x16_bf16 v[48:63], v[44:47], v[244:247], v[48:63]
    ds_read_b128 v[44:47], v5 offset:8192
    v_mfma_f32_32x32x16_bf16 v[64:79], v[16:19], v[244:247], v[64:79]
    v_mfma_f32_32x32x16_bf16 v[80:95], v[20:23], v[244:247], v[80:95]
    s_waitcnt lgkmcnt(5)
    s_nop 0
    v_mfma_f32_32x32x16_bf16 v[48:63], v[24:27], v[248:251], v[48:63]
    v_mfma_f32_32x32x16_bf16 v[64:79], v[28:31], v[248:251], v[64:79]
    s_barrier
    s_nop 0
    v_add_u32 v6, 86016, v2
    v_add_u32 v7, 86016, v3
    v_add_u32 v8, 86016, v4
    v_add_u32 v9, 86016, v5
    v_mfma_f32_32x32x16_bf16 v[80:95], v[32:35], v[248:251], v[80:95]
    ds_read_b128 v[16:19], v6 offset:0
    ds_read_b128 v[20:23], v7 offset:0
    ds_read_b128 v[24:27], v8 offset:0
    s_waitcnt lgkmcnt(3)
    s_nop 0
    v_mfma_f32_32x32x16_bf16 v[48:63], v[36:39], v[252:255], v[48:63]
    ds_read_b128 v[28:31], v9 offset:0
    v_mfma_f32_32x32x16_bf16 v[64:79], v[40:43], v[252:255], v[64:79]
    v_mfma_f32_32x32x16_bf16 v[80:95], v[44:47], v[252:255], v[80:95]
    s_waitcnt lgkmcnt(3)
    s_nop 0
    v_mfma_f32_32x32x16_bf16 v[32:47], v[16:19], v[96:99], 0
    ds_read_b128 v[96:99], v6 offset:4096
    s_waitcnt lgkmcnt(3)
    s_nop 0
    v_mfma_f32_32x32x16_bf16 v[32:47], v[20:23], v[100:103], v[32:47]
    ds_read_b128 v[100:103], v7 offset:4096
    s_waitcnt lgkmcnt(3)
    s_nop 0
    v_mfma_f32_32x32x16_bf16 v[32:47], v[24:27], v[104:107], v[32:47]
    ds_read_b128 v[104:107], v8 offset:4096
    s_waitcnt lgkmcnt(3)
    s_nop 0
    v_mfma_f32_32x32x16_bf16 v[32:47], v[28:31], v[108:111], v[32:47]
    ds_read_b128 v[108:111], v9 offset:4096
    ds_read_b128 v[16:19], v6 offset:8192
    v_cvt_pk_bf16_f32 v48, v48, v49
    v_cvt_pk_bf16_f32 v49, v50, v51
    v_cvt_pk_bf16_f32 v50, v52, v53
    v_cvt_pk_bf16_f32 v51, v54, v55
    s_waitcnt lgkmcnt(4)
    s_nop 0
    v_mfma_f32_32x32x16_bf16 v[32:47], v[96:99], v[112:115], v[32:47]
    ds_read_b128 v[20:23], v7 offset:8192
    ds_read_b128 v[24:27], v8 offset:8192
    buffer_store_dwordx4 v[48:51], v12, s[36:39], s34 offen offset:0 sc1
    v_cvt_pk_bf16_f32 v56, v56, v57
    v_cvt_pk_bf16_f32 v57, v58, v59
    v_cvt_pk_bf16_f32 v58, v60, v61
    s_waitcnt lgkmcnt(5)
    s_nop 0
    v_mfma_f32_32x32x16_bf16 v[32:47], v[100:103], v[116:119], v[32:47]
    ds_read_b128 v[28:31], v9 offset:8192
    ds_read_b128 v[96:99], v6 offset:12288
    v_cvt_pk_bf16_f32 v59, v62, v63
    buffer_store_dwordx4 v[56:59], v13, s[36:39], s34 offen offset:0 sc1
    v_cvt_pk_bf16_f32 v64, v64, v65
    v_cvt_pk_bf16_f32 v65, v66, v67
    s_waitcnt lgkmcnt(6)
    s_nop 0
    v_mfma_f32_32x32x16_bf16 v[32:47], v[104:107], v[120:123], v[32:47]
    ds_read_b128 v[100:103], v7 offset:12288
    ds_read_b128 v[104:107], v8 offset:12288
    v_cvt_pk_bf16_f32 v66, v68, v69
    v_cvt_pk_bf16_f32 v67, v70, v71
    buffer_store_dwordx4 v[64:67], v12, s[36:39], s34 offen offset:2560 sc1
    v_cvt_pk_bf16_f32 v72, v72, v73
    s_waitcnt lgkmcnt(7)
    s_nop 0
    v_mfma_f32_32x32x16_bf16 v[32:47], v[108:111], v[124:127], v[32:47]
    ds_read_b128 v[108:111], v9 offset:12288
    v_cvt_pk_bf16_f32 v73, v74, v75
    v_cvt_pk_bf16_f32 v74, v76, v77
    v_cvt_pk_bf16_f32 v75, v78, v79
    buffer_store_dwordx4 v[72:75], v13, s[36:39], s34 offen offset:2560 sc1
    s_waitcnt lgkmcnt(6)
    s_nop 0
    v_mfma_f32_32x32x16_bf16 v[32:47], v[16:19], v[128:131], v[32:47]
    ds_read_b128 v[16:19], v6 offset:17408
    v_cvt_pk_bf16_f32 v80, v80, v81
    v_cvt_pk_bf16_f32 v81, v82, v83
    v_cvt_pk_bf16_f32 v82, v84, v85
    v_cvt_pk_bf16_f32 v83, v86, v87
    v_mfma_f32_32x32x16_bf16 v[32:47], v[20:23], v[132:135], v[32:47]
    ds_read_b128 v[20:23], v7 offset:17408
    buffer_store_dwordx4 v[80:83], v12, s[36:39], s35 offen offset:0 sc1
    v_cvt_pk_bf16_f32 v88, v88, v89
    v_cvt_pk_bf16_f32 v89, v90, v91
    v_cvt_pk_bf16_f32 v90, v92, v93
    s_waitcnt lgkmcnt(6)
    s_nop 0
    v_mfma_f32_32x32x16_bf16 v[32:47], v[24:27], v[136:139], v[32:47]
    ds_read_b128 v[24:27], v8 offset:17408
    v_cvt_pk_bf16_f32 v91, v94, v95
    buffer_store_dwordx4 v[88:91], v13, s[36:39], s35 offen offset:0 sc1
    v_mfma_f32_32x32x16_bf16 v[32:47], v[28:31], v[140:143], v[32:47]
    ds_read_b128 v[28:31], v9 offset:17408
    s_barrier
    s_waitcnt lgkmcnt(6)
    v_mfma_f32_32x32x16_bf16 v[32:47], v[96:99], v[144:147], v[32:47]
    ds_read_b128 v[96:99], v6 offset:21504
    v_mfma_f32_32x32x16_bf16 v[32:47], v[100:103], v[148:151], v[32:47]
    ds_read_b128 v[100:103], v7 offset:21504
    s_waitcnt lgkmcnt(6)
    s_nop 0
    v_mfma_f32_32x32x16_bf16 v[32:47], v[104:107], v[152:155], v[32:47]
    ds_read_b128 v[104:107], v8 offset:21504
    v_mfma_f32_32x32x16_bf16 v[32:47], v[108:111], v[156:159], v[32:47]
    ds_read_b128 v[108:111], v9 offset:21504
    s_waitcnt lgkmcnt(6)
    s_nop 0
    v_mfma_f32_32x32x16_bf16 v[32:47], v[16:19], v[160:163], v[32:47]
    ds_read_b128 v[16:19], v6 offset:25600
    v_mfma_f32_32x32x16_bf16 v[32:47], v[20:23], v[164:167], v[32:47]
    ds_read_b128 v[20:23], v7 offset:25600
    s_waitcnt lgkmcnt(6)
    s_nop 0
    v_mfma_f32_32x32x16_bf16 v[32:47], v[24:27], v[168:171], v[32:47]
    ds_read_b128 v[24:27], v8 offset:25600
    v_mfma_f32_32x32x16_bf16 v[32:47], v[28:31], v[172:175], v[32:47]
    ds_read_b128 v[28:31], v9 offset:25600
    s_waitcnt lgkmcnt(6)
    s_nop 0
    v_mfma_f32_32x32x16_bf16 v[32:47], v[96:99], v[176:179], v[32:47]
    ds_read_b128 v[96:99], v6 offset:29696
    v_mfma_f32_32x32x16_bf16 v[32:47], v[100:103], v[180:183], v[32:47]
    ds_read_b128 v[100:103], v7 offset:29696
    s_waitcnt lgkmcnt(6)
    s_nop 0
    v_mfma_f32_32x32x16_bf16 v[32:47], v[104:107], v[184:187], v[32:47]
    ds_read_b128 v[104:107], v8 offset:29696
    v_mfma_f32_32x32x16_bf16 v[32:47], v[108:111], v[188:191], v[32:47]
    ds_read_b128 v[108:111], v9 offset:29696
    s_waitcnt lgkmcnt(6)
    s_nop 0
    v_mfma_f32_32x32x16_bf16 v[32:47], v[16:19], v[192:195], v[32:47]
    ds_read_b128 v[16:19], v6 offset:33792
    v_mfma_f32_32x32x16_bf16 v[32:47], v[20:23], v[196:199], v[32:47]
    ds_read_b128 v[20:23], v7 offset:33792
    s_waitcnt lgkmcnt(6)
    s_nop 0
    v_mfma_f32_32x32x16_bf16 v[32:47], v[24:27], v[200:203], v[32:47]
    ds_read_b128 v[24:27], v8 offset:33792
    v_mfma_f32_32x32x16_bf16 v[32:47], v[28:31], v[204:207], v[32:47]
    ds_read_b128 v[28:31], v9 offset:33792
    s_waitcnt lgkmcnt(6)
    s_nop 0
    v_mfma_f32_32x32x16_bf16 v[32:47], v[96:99], v[208:211], v[32:47]
    ds_read_b128 v[96:99], v6 offset:37888
    v_mfma_f32_32x32x16_bf16 v[32:47], v[100:103], v[212:215], v[32:47]
    ds_read_b128 v[100:103], v7 offset:37888
    s_waitcnt lgkmcnt(6)
    s_nop 0
    v_mfma_f32_32x32x16_bf16 v[32:47], v[104:107], v[216:219], v[32:47]
    ds_read_b128 v[104:107], v8 offset:37888
    v_mov_b32_e64 v3, 0
    buffer_load_dword v2, v3, s[48:51], 0 offen sc1
    v_mfma_f32_32x32x16_bf16 v[32:47], v[108:111], v[220:223], v[32:47]
    ds_read_b128 v[108:111], v9 offset:37888
    s_waitcnt lgkmcnt(6)
    s_nop 0
    v_mfma_f32_32x32x16_bf16 v[32:47], v[16:19], v[224:227], v[32:47]
    v_mfma_f32_32x32x16_bf16 v[32:47], v[20:23], v[228:231], v[32:47]
    s_waitcnt lgkmcnt(4)
    s_nop 0
    v_mfma_f32_32x32x16_bf16 v[32:47], v[24:27], v[232:235], v[32:47]
    v_mfma_f32_32x32x16_bf16 v[32:47], v[28:31], v[236:239], v[32:47]
    s_waitcnt lgkmcnt(2)
    s_nop 0
    v_mfma_f32_32x32x16_bf16 v[32:47], v[96:99], v[240:243], v[32:47]
    v_mfma_f32_32x32x16_bf16 v[32:47], v[100:103], v[244:247], v[32:47]
    s_waitcnt lgkmcnt(0)
    s_nop 0
    v_mfma_f32_32x32x16_bf16 v[32:47], v[104:107], v[248:251], v[32:47]
    v_mfma_f32_32x32x16_bf16 v[32:47], v[108:111], v[252:255], v[32:47]
    s_nop 7
    s_nop 3
    v_cvt_pk_bf16_f32 v32, v32, v33
    v_cvt_pk_bf16_f32 v33, v34, v35
    v_cvt_pk_bf16_f32 v34, v36, v37
    v_cvt_pk_bf16_f32 v35, v38, v39
    buffer_store_dwordx4 v[32:35], v12, s[36:39], s35 offen offset:2560 sc1
    v_cvt_pk_bf16_f32 v40, v40, v41
    v_cvt_pk_bf16_f32 v41, v42, v43
    v_cvt_pk_bf16_f32 v42, v44, v45
    v_cvt_pk_bf16_f32 v43, v46, v47
    buffer_store_dwordx4 v[40:43], v13, s[36:39], s35 offen offset:2560 sc1
C_sig1:
    s_mov_b32 s30, 10485760
    s_waitcnt vmcnt(0)
    s_mov_b32 s72, 262144
NC_5:
    v_readfirstlane_b32 s62, v2
    s_sub_u32 s72, s72, 1
    s_cmp_lg_u32 s62, 0
    s_cbranch_scc1 NCd_6
    s_cmp_eq_u32 s72, 0
    s_cbranch_scc1 NCd_6
    s_sleep 8
    buffer_load_dword v2, v3, s[48:51], 0 offen sc1
    s_waitcnt vmcnt(0)
    s_branch NC_5
NCd_6:
    s_mov_b32 s64, s62
    s_mov_b32 s65, s62
    s_mov_b64 exec, s[26:27]
    v_mov_b32 v4, s62
    s_barrier
    s_cmp_lg_u32 s61, 0
    s_cbranch_scc1 C_p2
    buffer_atomic_swap v4, v14, s[36:39], s30 offen sc1
C_p2:
    s_mov_b64 exec, -1
    v_mov_b32 v31, 102400
    s_and_b32 s72, s25, 1
    s_lshl_b32 s73, s24, 1
    s_add_u32 s72, s72, s73
    s_lshr_b32 s75, s25, 1
    s_and_b32 s76, s61, 1
    s_lshl_b32 s71, s72, 1
    s_add_u32 s71, s71, s76
    s_lshr_b32 s77, s61, 1
    s_xor_b32 s78, s63, 1
    s_lshl_b32 s78, s78, 1
    s_lshl_b32 s70, s75, 2
    s_add_u32 s70, s70, s77
    s_lshl_b32 s73, s75, 4
    s_add_u32 s73, s73, s72
    s_lshl_b32 s73, s73, 7
    s_add_u32 s73, s73, 10485760
    s_add_u32 s66, s14, s73
    s_addc_u32 s67, s15, 0
    s_lshl_b32 s73, s24, 3
    s_and_b32 s74, s25, 2
    s_lshl_b32 s74, s74, 1
    s_add_u32 s73, s73, s74
    s_and_b32 s74, s25, 1
    s_add_u32 s73, s73, s74
    s_add_u32 s59, s73, s78
    s_lshl_b32 s73, s59, 3
    s_lshr_b32 s74, s25, 2
    s_add_u32 s73, s73, s74
    s_lshl_b32 s73, s73, 7
    s_lshr_b32 s74, s61, 1
    s_lshl_b32 s74, s74, 6
    s_add_u32 s73, s73, s74
    s_add_u32 s73, s73, 10551296
    s_add_u32 s68, s14, s73
    s_addc_u32 s69, s15, 0
    s_mul_i32 s79, s72, 163840
    s_mul_i32 s3, s70, 2560
    s_add_u32 s3, s3, s79
    s_and_b32 s76, s61, 1
    s_lshr_b32 s77, s61, 1
    v_and_b32 v40, 31, v1
    v_lshrrev_b32 v41, 5, v1
    v_lshlrev_b32 v27, 4, v40
    v_lshl_add_u32 v28, v41, 9, v27
    s_mul_i32 s73, s77, 2560
    s_add_u32 s73, s73, 102400
    s_mul_i32 s74, s76, 1536
    s_add_u32 s74, s74, s73
    v_add_u32 v24, s74, v28
    s_lshl_b32 s74, s76, 3
    s_add_u32 s74, s74, s73
    v_add_u32 v25, s74, v27
    v_and_b32 v42, 0x13, v40
    v_bfe_u32 v43, v40, 2, 1
    v_lshl_or_b32 v42, v43, 3, v42
    v_bfe_u32 v43, v40, 3, 1
    v_lshl_or_b32 v42, v43, 2, v42
    v_cmp_gt_u32 vcc, 20, v40
    v_mul_u32_u24 v43, 640, v41
    v_mov_b32 v46, 0
    v_cndmask_b32 v44, v46, v42, vcc
    v_lshl_add_u32 v43, v44, 4, v43
    s_mul_i32 s74, s76, 320
    s_add_u32 s74, s74, s73
    s_add_u32 s74, s74, 30720
    v_add_u32 v26, s74, v43
    v_lshlrev_b32 v43, 2, v41
    v_sub_u32 v43, v40, v43
    v_mov_b32 v44, 4048155338
    v_cmp_le_i32 vcc, 0, v43
    v_mov_b32 v224, 0x3f803f80
    v_mov_b32 v240, 0x3f803f80
    v_cndmask_b32 v208, v44, v46, vcc
    v_cndmask_b32 v192, v46, v44, vcc
    v_cmp_le_i32 vcc, 1, v43
    v_mov_b32 v225, 0x3f803f80
    v_mov_b32 v241, 0x3f803f80
    v_cndmask_b32 v209, v44, v46, vcc
    v_cndmask_b32 v193, v46, v44, vcc
    v_cmp_le_i32 vcc, 2, v43
    v_mov_b32 v226, 0x3f803f80
    v_mov_b32 v242, 0x3f803f80
    v_cndmask_b32 v210, v44, v46, vcc
    v_cndmask_b32 v194, v46, v44, vcc
    v_cmp_le_i32 vcc, 3, v43
    v_mov_b32 v227, 0x3f803f80
    v_mov_b32 v243, 0x3f803f80
    v_cndmask_b32 v211, v44, v46, vcc
    v_cndmask_b32 v195, v46, v44, vcc
    v_cmp_le_i32 vcc, 8, v43
    v_mov_b32 v228, 0x3f803f80
    v_mov_b32 v244, 0x3f803f80
    v_cndmask_b32 v212, v44, v46, vcc
    v_cndmask_b32 v196, v46, v44, vcc
    v_cmp_le_i32 vcc, 9, v43
    v_mov_b32 v229, 0x3f803f80
    v_mov_b32 v245, 0x3f803f80
    v_cndmask_b32 v213, v44, v46, vcc
    v_cndmask_b32 v197, v46, v44, vcc
    v_cmp_le_i32 vcc, 10, v43
    v_mov_b32 v230, 0x3f803f80
    v_mov_b32 v246, 0x3f803f80
    v_cndmask_b32 v214, v44, v46, vcc
    v_cndmask_b32 v198, v46, v44, vcc
    v_cmp_le_i32 vcc, 11, v43
    v_mov_b32 v231, 0x3f803f80
    v_mov_b32 v247, 0x3f803f80
    v_cndmask_b32 v215, v44, v46, vcc
    v_cndmask_b32 v199, v46, v44, vcc
    v_cmp_le_i32 vcc, 16, v43
    v_mov_b32 v232, 0x3f803f80
    v_mov_b32 v248, 0x3f803f80
    v_cndmask_b32 v216, v44, v46, vcc
    v_cndmask_b32 v200, v46, v44, vcc
    v_cmp_le_i32 vcc, 17, v43
    v_mov_b32 v233, 0x3f803f80
    v_mov_b32 v249, 0x3f803f80
    v_cndmask_b32 v217, v44, v46, vcc
    v_cndmask_b32 v201, v46, v44, vcc
    v_cmp_le_i32 vcc, 18, v43
    v_mov_b32 v234, 0x3f803f80
    v_mov_b32 v250, 0x3f803f80
    v_cndmask_b32 v218, v44, v46, vcc
    v_cndmask_b32 v202, v46, v44, vcc
    v_cmp_le_i32 vcc, 19, v43
    v_mov_b32 v235, 0x3f803f80
    v_mov_b32 v251, 0x3f803f80
    v_cndmask_b32 v219, v44, v46, vcc
    v_cndmask_b32 v203, v46, v44, vcc
    v_cmp_le_i32 vcc, 24, v43
    v_mov_b32 v236, 0x3f803f80
    v_mov_b32 v252, 0x3f803f80
    v_cndmask_b32 v220, v44, v46, vcc
    v_cndmask_b32 v204, v46, v44, vcc
    v_cmp_le_i32 vcc, 25, v43
    v_mov_b32 v237, 0x3f803f80
    v_mov_b32 v253, 0x3f803f80
    v_cndmask_b32 v221, v44, v46, vcc
    v_cndmask_b32 v205, v46, v44, vcc
    v_cmp_le_i32 vcc, 26, v43
    v_mov_b32 v238, 0x3f803f80
    v_mov_b32 v254, 0x3f803f80
    v_cndmask_b32 v222, v44, v46, vcc
    v_cndmask_b32 v206, v46, v44, vcc
    v_cmp_le_i32 vcc, 27, v43
    v_mov_b32 v239, 0x3f803f80
    v_mov_b32 v255, 0x3f803f80
    v_cndmask_b32 v223, v44, v46, vcc
    v_cndmask_b32 v207, v46, v44, vcc
    v_mov_b32 v152, 0x3f803f80
    v_mov_b32 v153, 0x3f803f80
    v_mov_b32 v154, 0x3f803f80
    v_mov_b32 v155, 0x3f803f80
    v_mov_b32 v156, 0x3f803f80
    v_mov_b32 v157, 0x3f803f80
    v_mov_b32 v158, 0x3f803f80
    v_mov_b32 v159, 0x3f803f80
    v_mov_b32 v160, 0x3f803f80
    v_mov_b32 v161, 0x3f803f80
    v_mov_b32 v162, 0x3f803f80
    v_mov_b32 v163, 0x3f803f80
    v_mov_b32 v164, 0x3f803f80
    v_mov_b32 v165, 0x3f803f80
    v_mov_b32 v166, 0x3f803f80
    v_mov_b32 v167, 0x3f803f80
    v_mov_b32 v168, 0x3f803f80
    v_mov_b32 v169, 0x3f803f80
    v_mov_b32 v170, 0x3f803f80
    v_mov_b32 v171, 0x3f803f80
    v_mov_b32 v172, 0x3f803f80
    v_mov_b32 v173, 0x3f803f80
    v_mov_b32 v174, 0x3f803f80
    v_mov_b32 v175, 0x3f803f80
    v_mov_b32 v176, 0x3f803f80
    v_mov_b32 v177, 0x3f803f80
    v_mov_b32 v178, 0x3f803f80
    v_mov_b32 v179, 0x3f803f80
    v_mov_b32 v180, 0x3f803f80
    v_mov_b32 v181, 0x3f803f80
    v_mov_b32 v182, 0x3f803f80
    v_mov_b32 v183, 0x3f803f80
    v_mov_b32 v184, 0x3f803f80
    v_mov_b32 v185, 0x3f803f80
    v_mov_b32 v186, 0x3f803f80
    v_mov_b32 v187, 0x3f803f80
    v_mov_b32 v188, 0x3f803f80
    v_mov_b32 v189, 0x3f803f80
    v_mov_b32 v190, 0x3f803f80
    v_mov_b32 v191, 0x3f803f80
    s_mov_b32 s76, 64
    s_mov_b32 s72, 2097152
LW_7:
    ds_read_b32 v30, v31 offset:8
    s_sub_u32 s72, s72, 1
    s_waitcnt lgkmcnt(0)
    v_readfirstlane_b32 s73, v30
    s_cbranch_scc1 LWd_8
    s_and_b32 s73, s73, s76
    s_cmp_lg_u32 s73, 0
    s_cbranch_scc1 LWd_8
    s_sleep 1
    s_branch LW_7
LWd_8:
    s_and_b32 s72, s61, 1
    s_mul_i32 s73, s72, 1536
    s_add_u32 s73, s73, s3
    s_lshl_b32 s72, s72, 3
    s_add_u32 s72, s72, s3
    buffer_load_dwordx4 v[32:35], v28, s[36:39], s73 offen sc1
    buffer_load_dwordx2 v[36:37], v27, s[36:39], s72 offen offset:1024 sc1
    s_add_u32 s73, s73, 5120
    s_add_u32 s72, s72, 5120
    buffer_load_dwordx4 v[48:51], v28, s[36:39], s73 offen sc1
    buffer_load_dwordx2 v[52:53], v27, s[36:39], s72 offen offset:1024 sc1
L_att:
    s_sub_u32 s77, 8, s70
    s_mov_b32 s78, 0x000fffff
    s_mov_b32 s79, 0x000fffff
    s_mov_b32 s72, 394264576
    s_mov_b32 s73, 1400897536
    s_lshl_b32 s74, s70, 5
    s_add_u32 s74, s74, s71
    s_mul_i32 s74, s74, 1280
    s_add_u32 s74, s74, 7864320
    s_add_u32 s32, s74, 81920
    s_lshl_b32 s75, s70, 10
    s_lshl_b32 s76, s71, 2
    s_add_u32 s75, s75, s76
    s_add_u32 s75, s75, 10551296
    s_add_u32 s33, s75, 2048
    v_lshlrev_b32 v8, 7, v1
    v_mov_b32 v9, s62
    v_lshrrev_b32 v7, 1, v27
    s_waitcnt vmcnt(0) lgkmcnt(0)
    s_mov_b32 exec_lo, 0
    v_mov_b32 v36, 0
    v_mov_b32 v37, 0
    v_mov_b32 v52, 0
    v_mov_b32 v53, 0
    s_mov_b64 exec, -1
    s_barrier
    s_setprio 1
    ds_read_b128 v[40:43], v24 offset:20480
    ds_read_b64 v[44:45], v25 offset:21504
    s_waitcnt lgkmcnt(0)
    v_mfma_f32_32x32x16_bf16 v[80:95], v[40:43], v[32:35], v[208:223]
    v_mfma_f32_32x32x8bf16_1k v[80:95], v[44:45], v[36:37], v[80:95]
    ds_read_b128 v[40:43], v24 offset:17920
    ds_read_b64 v[44:45], v25 offset:18944
    s_nop 7
    s_waitcnt lgkmcnt(0)
    s_nop 0
.p2align 3
    v_mfma_f32_32x32x16_bf16 v[96:111], v[40:43], v[32:35], 0
    v_exp_f32 v80, v80
    v_exp_f32 v81, v81
    v_exp_f32 v82, v82
    v_exp_f32 v83, v83
    v_mfma_f32_32x32x8bf16_1k v[96:111], v[44:45], v[36:37], v[96:111]
    ds_read_b128 v[40:43], v24 offset:15360
    ds_read_b64 v[44:45], v25 offset:16384
    v_exp_f32 v84, v84
    v_exp_f32 v85, v85
    v_exp_f32 v86, v86
    v_exp_f32 v87, v87
    v_cvt_pk_bf16_f32 v60, v80, v81
    v_cvt_pk_bf16_f32 v61, v82, v83
    v_exp_f32 v88, v88
    v_exp_f32 v89, v89
    v_exp_f32 v90, v90
    v_exp_f32 v91, v91
    v_cvt_pk_bf16_f32 v62, v84, v85
    v_cvt_pk_bf16_f32 v63, v86, v87
    s_mov_b64 exec, s[78:79]
    s_nop 0
    ds_read_b128 v[248:251], v26 offset:20480
    ds_read_b128 v[252:255], v26 offset:21760
    s_mov_b64 exec, -1
    s_waitcnt lgkmcnt(2)
    v_exp_f32 v92, v92
    v_exp_f32 v93, v93
    v_exp_f32 v94, v94
    v_exp_f32 v95, v95
    v_cvt_pk_bf16_f32 v64, v88, v89
    v_cvt_pk_bf16_f32 v65, v90, v91
    v_cvt_pk_bf16_f32 v66, v92, v93
    v_cvt_pk_bf16_f32 v67, v94, v95
    v_mfma_f32_32x32x16_bf16 v[80:95], v[40:43], v[32:35], 0
    v_exp_f32 v96, v96
    v_exp_f32 v97, v97
    v_exp_f32 v98, v98
    v_exp_f32 v99, v99
    v_mfma_f32_32x32x8bf16_1k v[80:95], v[44:45], v[36:37], v[80:95]
    ds_read_b128 v[40:43], v24 offset:12800
    ds_read_b64 v[44:45], v25 offset:13824
    s_waitcnt lgkmcnt(2)
    v_exp_f32 v100, v100
    v_exp_f32 v101, v101
    v_exp_f32 v102, v102
    v_exp_f32_e64 v103, v103
    v_cvt_pk_bf16_f32 v68, v96, v97
    v_cvt_pk_bf16_f32 v69, v98, v99
    v_mfma_f32_32x32x16_bf16 v[112:127], v[248:251], v[60:63], 0
    v_exp_f32 v104, v104
    v_exp_f32 v105, v105
    v_exp_f32 v106, v106
    v_exp_f32 v107, v107
    v_cvt_pk_bf16_f32 v70, v100, v101
    v_cvt_pk_bf16_f32 v71, v102, v103
    v_mfma_f32_32x32x16_bf16 v[112:127], v[252:255], v[64:67], v[112:127]
    s_cmp_gt_i32 s77, 7
    s_cselect_b64 exec, -1, s[78:79]
    ds_read_b128 v[240:243], v26 offset:17920
    ds_read_b128 v[244:247], v26 offset:19200
    s_mov_b64 exec, -1
    s_waitcnt lgkmcnt(2)
    v_exp_f32 v108, v108
    v_exp_f32 v109, v109
    v_exp_f32 v110, v110
    v_exp_f32 v111, v111
    v_cvt_pk_bf16_f32 v72, v104, v105
    v_cvt_pk_bf16_f32 v73, v106, v107
    v_cvt_pk_bf16_f32 v74, v108, v109
    v_cvt_pk_bf16_f32 v75, v110, v111
    v_mfma_f32_32x32x16_bf16 v[96:111], v[40:43], v[32:35], 0
    v_exp_f32 v80, v80
    v_exp_f32 v81, v81
    v_exp_f32 v82, v82
    v_exp_f32 v83, v83
    v_mfma_f32_32x32x8bf16_1k v[96:111], v[44:45], v[36:37], v[96:111]
    ds_read_b128 v[40:43], v24 offset:10240
    ds_read_b64 v[44:45], v25 offset:11264
    s_waitcnt lgkmcnt(2)
    v_exp_f32 v84, v84
    v_exp_f32 v85, v85
    v_exp_f32 v86, v86
    v_exp_f32_e64 v87, v87
    v_cvt_pk_bf16_f32 v60, v80, v81
    v_cvt_pk_bf16_f32 v61, v82, v83
    v_mfma_f32_32x32x16_bf16 v[112:127], v[240:243], v[68:71], v[112:127]
    v_exp_f32 v88, v88
    v_exp_f32 v89, v89
    v_exp_f32 v90, v90
    v_exp_f32 v91, v91
    v_cvt_pk_bf16_f32 v62, v84, v85
    v_cvt_pk_bf16_f32 v63, v86, v87
    v_mfma_f32_32x32x16_bf16 v[112:127], v[244:247], v[72:75], v[112:127]
    s_cmp_gt_i32 s77, 6
    s_cselect_b64 exec, -1, s[78:79]
    ds_read_b128 v[184:187], v26 offset:15360
    ds_read_b128 v[188:191], v26 offset:16640
    s_mov_b64 exec, -1
    s_waitcnt lgkmcnt(2)
    v_exp_f32 v92, v92
    v_exp_f32 v93, v93
    v_exp_f32 v94, v94
    v_exp_f32 v95, v95
    v_cvt_pk_bf16_f32 v64, v88, v89
    v_cvt_pk_bf16_f32 v65, v90, v91
    v_cvt_pk_bf16_f32 v66, v92, v93
    v_cvt_pk_bf16_f32 v67, v94, v95
    v_mfma_f32_32x32x16_bf16 v[80:95], v[40:43], v[32:35], 0
    v_exp_f32 v96, v96
    v_exp_f32 v97, v97
    v_exp_f32 v98, v98
    v_exp_f32 v99, v99
    v_mfma_f32_32x32x8bf16_1k v[80:95], v[44:45], v[36:37], v[80:95]
    ds_read_b128 v[40:43], v24 offset:7680
    ds_read_b64 v[44:45], v25 offset:8704
    s_waitcnt lgkmcnt(2)
    v_exp_f32 v100, v100
    v_exp_f32 v101, v101
    v_exp_f32 v102, v102
    v_exp_f32_e64 v103, v103
    v_cvt_pk_bf16_f32 v68, v96, v97
    v_cvt_pk_bf16_f32 v69, v98, v99
    v_mfma_f32_32x32x16_bf16 v[112:127], v[184:187], v[60:63], v[112:127]
    v_exp_f32 v104, v104
    v_exp_f32 v105, v105
    v_exp_f32 v106, v106
    v_exp_f32 v107, v107
    v_cvt_pk_bf16_f32 v70, v100, v101
    v_cvt_pk_bf16_f32 v71, v102, v103
    v_mfma_f32_32x32x16_bf16 v[112:127], v[188:191], v[64:67], v[112:127]
    s_cmp_gt_i32 s77, 5
    s_cselect_b64 exec, -1, s[78:79]
    ds_read_b128 v[176:179], v26 offset:12800
    ds_read_b128 v[180:183], v26 offset:14080
    s_mov_b64 exec, -1
    s_waitcnt lgkmcnt(2)
    v_exp_f32 v108, v108
    v_exp_f32 v109, v109
    v_exp_f32 v110, v110
    v_exp_f32 v111, v111
    v_cvt_pk_bf16_f32 v72, v104, v105
    v_cvt_pk_bf16_f32 v73, v106, v107
    v_cvt_pk_bf16_f32 v74, v108, v109
    v_cvt_pk_bf16_f32 v75, v110, v111
    v_mfma_f32_32x32x16_bf16 v[96:111], v[40:43], v[32:35], 0
    v_exp_f32 v80, v80
    v_exp_f32 v81, v81
    v_exp_f32 v82, v82
    v_exp_f32 v83, v83
    v_mfma_f32_32x32x8bf16_1k v[96:111], v[44:45], v[36:37], v[96:111]
    ds_read_b128 v[40:43], v24 offset:5120
    ds_read_b64 v[44:45], v25 offset:6144
    s_waitcnt lgkmcnt(2)
    v_exp_f32 v84, v84
    v_exp_f32 v85, v85
    v_exp_f32 v86, v86
    v_exp_f32_e64 v87, v87
    v_cvt_pk_bf16_f32 v60, v80, v81
    v_cvt_pk_bf16_f32 v61, v82, v83
    v_mfma_f32_32x32x16_bf16 v[112:127], v[176:179], v[68:71], v[112:127]
    v_exp_f32 v88, v88
    v_exp_f32 v89, v89
    v_exp_f32 v90, v90
    v_exp_f32 v91, v91
    v_cvt_pk_bf16_f32 v62, v84, v85
    v_cvt_pk_bf16_f32 v63, v86, v87
    v_mfma_f32_32x32x16_bf16 v[112:127], v[180:183], v[72:75], v[112:127]
    s_cmp_gt_i32 s77, 4
    s_cselect_b64 exec, -1, s[78:79]
    ds_read_b128 v[168:171], v26 offset:10240
    ds_read_b128 v[172:175], v26 offset:11520
    s_mov_b64 exec, -1
    s_waitcnt lgkmcnt(2)
    v_exp_f32 v92, v92
    v_exp_f32 v93, v93
    v_exp_f32 v94, v94
    v_exp_f32 v95, v95
    v_cvt_pk_bf16_f32 v64, v88, v89
    v_cvt_pk_bf16_f32 v65, v90, v91
    v_cvt_pk_bf16_f32 v66, v92, v93
    v_cvt_pk_bf16_f32 v67, v94, v95
    v_mfma_f32_32x32x16_bf16 v[80:95], v[40:43], v[32:35], 0
    v_exp_f32 v96, v96
    v_exp_f32 v97, v97
    v_exp_f32 v98, v98
    v_exp_f32 v99, v99
    v_mfma_f32_32x32x8bf16_1k v[80:95], v[44:45], v[36:37], v[80:95]
    ds_read_b128 v[40:43], v24 offset:2560
    ds_read_b64 v[44:45], v25 offset:3584
    s_waitcnt lgkmcnt(2)
    v_exp_f32 v100, v100
    v_exp_f32 v101, v101
    v_exp_f32 v102, v102
    v_exp_f32_e64 v103, v103
    v_cvt_pk_bf16_f32 v68, v96, v97
    v_cvt_pk_bf16_f32 v69, v98, v99
    v_mfma_f32_32x32x16_bf16 v[112:127], v[168:171], v[60:63], v[112:127]
    v_exp_f32 v104, v104
    v_exp_f32 v105, v105
    v_exp_f32 v106, v106
    v_exp_f32 v107, v107
    v_cvt_pk_bf16_f32 v70, v100, v101
    v_cvt_pk_bf16_f32 v71, v102, v103
    v_mfma_f32_32x32x16_bf16 v[112:127], v[172:175], v[64:67], v[112:127]
    s_cmp_gt_i32 s77, 3
    s_cselect_b64 exec, -1, s[78:79]
    ds_read_b128 v[160:163], v26 offset:7680
    ds_read_b128 v[164:167], v26 offset:8960
    s_mov_b64 exec, -1
    s_waitcnt lgkmcnt(2)
    v_exp_f32 v108, v108
    v_exp_f32 v109, v109
    v_exp_f32 v110, v110
    v_exp_f32 v111, v111
    v_cvt_pk_bf16_f32 v72, v104, v105
    v_cvt_pk_bf16_f32 v73, v106, v107
    v_cvt_pk_bf16_f32 v74, v108, v109
    v_cvt_pk_bf16_f32 v75, v110, v111
    v_mfma_f32_32x32x16_bf16 v[96:111], v[40:43], v[32:35], 0
    v_exp_f32 v80, v80
    v_exp_f32 v81, v81
    v_exp_f32 v82, v82
    v_exp_f32 v83, v83
    v_mfma_f32_32x32x8bf16_1k v[96:111], v[44:45], v[36:37], v[96:111]
    ds_read_b128 v[40:43], v24 offset:0
    ds_read_b64 v[44:45], v25 offset:1024
    s_waitcnt lgkmcnt(2)
    v_exp_f32 v84, v84
    v_exp_f32 v85, v85
    v_exp_f32 v86, v86
    v_exp_f32_e64 v87, v87
    v_cvt_pk_bf16_f32 v60, v80, v81
    v_cvt_pk_bf16_f32 v61, v82, v83
    v_mfma_f32_32x32x16_bf16 v[112:127], v[160:163], v[68:71], v[112:127]
    v_exp_f32 v88, v88
    v_exp_f32 v89, v89
    v_exp_f32 v90, v90
    v_exp_f32 v91, v91
    v_cvt_pk_bf16_f32 v62, v84, v85
    v_cvt_pk_bf16_f32 v63, v86, v87
    v_mfma_f32_32x32x16_bf16 v[112:127], v[164:167], v[72:75], v[112:127]
    s_cmp_gt_i32 s77, 2
    s_cselect_b64 exec, -1, s[78:79]
    ds_read_b128 v[152:155], v26 offset:5120
    ds_read_b128 v[156:159], v26 offset:6400
    s_mov_b64 exec, -1
    s_waitcnt lgkmcnt(2)
    v_exp_f32 v92, v92
    v_exp_f32 v93, v93
    v_exp_f32 v94, v94
    v_exp_f32 v95, v95
    v_cvt_pk_bf16_f32 v64, v88, v89
    v_cvt_pk_bf16_f32 v65, v90, v91
    v_cvt_pk_bf16_f32 v66, v92, v93
    v_cvt_pk_bf16_f32 v67, v94, v95
    v_mfma_f32_32x32x16_bf16 v[80:95], v[40:43], v[32:35], v[192:207]
    v_exp_f32 v96, v96
    v_exp_f32 v97, v97
    v_exp_f32 v98, v98
    v_exp_f32 v99, v99
    v_mfma_f32_32x32x8bf16_1k v[80:95], v[44:45], v[36:37], v[80:95]
    ds_read_b128 v[40:43], v24 offset:25600
    ds_read_b64 v[44:45], v25 offset:26624
    s_waitcnt lgkmcnt(2)
    v_exp_f32 v100, v100
    v_exp_f32 v101, v101
    v_exp_f32 v102, v102
    v_exp_f32_e64 v103, v103
    v_cvt_pk_bf16_f32 v68, v96, v97
    v_cvt_pk_bf16_f32 v69, v98, v99
    v_mfma_f32_32x32x16_bf16 v[112:127], v[152:155], v[60:63], v[112:127]
    v_exp_f32 v104, v104
    v_exp_f32 v105, v105
    v_exp_f32 v106, v106
    v_exp_f32 v107, v107
    v_cvt_pk_bf16_f32 v70, v100, v101
    v_cvt_pk_bf16_f32 v71, v102, v103
    v_mfma_f32_32x32x16_bf16 v[112:127], v[156:159], v[64:67], v[112:127]
    s_cmp_gt_i32 s77, 1
    s_cselect_b64 exec, -1, s[78:79]
    ds_read_b128 v[224:227], v26 offset:2560
    ds_read_b128 v[228:231], v26 offset:3840
    s_mov_b64 exec, -1
    s_waitcnt lgkmcnt(2)
    v_exp_f32 v108, v108
    v_exp_f32 v109, v109
    v_exp_f32 v110, v110
    v_exp_f32 v111, v111
    v_cvt_pk_bf16_f32 v72, v104, v105
    v_cvt_pk_bf16_f32 v73, v106, v107
    v_cvt_pk_bf16_f32 v74, v108, v109
    v_cvt_pk_bf16_f32 v75, v110, v111
    v_mfma_f32_32x32x16_bf16 v[96:111], v[40:43], v[48:51], v[208:223]
    v_exp_f32 v80, v80
    v_exp_f32 v81, v81
    v_exp_f32 v82, v82
    v_exp_f32 v83, v83
    v_mfma_f32_32x32x8bf16_1k v[96:111], v[44:45], v[52:53], v[96:111]
    ds_read_b128 v[40:43], v24 offset:23040
    ds_read_b64 v[44:45], v25 offset:24064
    s_waitcnt lgkmcnt(2)
    v_exp_f32 v84, v84
    v_exp_f32 v85, v85
    v_exp_f32 v86, v86
    v_exp_f32_e64 v87, v87
    v_cvt_pk_bf16_f32 v60, v80, v81
    v_cvt_pk_bf16_f32 v61, v82, v83
    v_mfma_f32_32x32x16_bf16 v[112:127], v[224:227], v[68:71], v[112:127]
    v_exp_f32 v88, v88
    v_exp_f32 v89, v89
    v_exp_f32 v90, v90
    v_exp_f32 v91, v91
    v_cvt_pk_bf16_f32 v62, v84, v85
    v_cvt_pk_bf16_f32 v63, v86, v87
    v_mfma_f32_32x32x16_bf16 v[112:127], v[228:231], v[72:75], v[112:127]
    s_cmp_gt_i32 s77, 0
    s_cselect_b64 exec, -1, s[78:79]
    ds_read_b128 v[224:227], v26 offset:0
    ds_read_b128 v[228:231], v26 offset:1280
    s_mov_b64 exec, -1
    s_waitcnt lgkmcnt(2)
    v_exp_f32 v92, v92
    v_exp_f32 v93, v93
    v_exp_f32 v94, v94
    v_exp_f32 v95, v95
    v_cvt_pk_bf16_f32 v64, v88, v89
    v_cvt_pk_bf16_f32 v65, v90, v91
    v_cvt_pk_bf16_f32 v66, v92, v93
    v_cvt_pk_bf16_f32 v67, v94, v95
    v_mfma_f32_32x32x16_bf16 v[80:95], v[40:43], v[48:51], 0
    v_exp_f32 v96, v96
    v_exp_f32 v97, v97
    v_exp_f32 v98, v98
    v_exp_f32 v99, v99
    v_mfma_f32_32x32x8bf16_1k v[80:95], v[44:45], v[52:53], v[80:95]
    ds_read_b128 v[40:43], v24 offset:20480
    ds_read_b64 v[44:45], v25 offset:21504
    s_waitcnt lgkmcnt(2)
    v_exp_f32 v100, v100
    v_exp_f32 v101, v101
    v_exp_f32 v102, v102
    v_exp_f32_e64 v103, v103
    v_cvt_pk_bf16_f32 v68, v96, v97
    v_cvt_pk_bf16_f32 v69, v98, v99
    v_mfma_f32_32x32x16_bf16 v[112:127], v[224:227], v[60:63], v[112:127]
    v_exp_f32 v104, v104
    v_exp_f32 v105, v105
    v_exp_f32 v106, v106
    v_exp_f32 v107, v107
    v_cvt_pk_bf16_f32 v70, v100, v101
    v_cvt_pk_bf16_f32 v71, v102, v103
    v_mfma_f32_32x32x16_bf16 v[112:127], v[228:231], v[64:67], v[112:127]
    s_mov_b64 exec, s[78:79]
    s_nop 0
    ds_read_b128 v[232:235], v26 offset:25600
    ds_read_b128 v[236:239], v26 offset:26880
    s_mov_b64 exec, -1
    s_waitcnt lgkmcnt(2)
    v_exp_f32 v108, v108
    v_exp_f32 v109, v109
    v_exp_f32 v110, v110
    v_exp_f32 v111, v111
    v_cvt_pk_bf16_f32 v72, v104, v105
    v_cvt_pk_bf16_f32 v73, v106, v107
    v_cvt_pk_bf16_f32 v74, v108, v109
    v_cvt_pk_bf16_f32 v75, v110, v111
    v_mfma_f32_32x32x16_bf16 v[96:111], v[40:43], v[48:51], 0
    v_exp_f32 v80, v80
    v_exp_f32 v81, v81
    v_exp_f32 v82, v82
    v_exp_f32 v83, v83
    v_mfma_f32_32x32x8bf16_1k v[96:111], v[44:45], v[52:53], v[96:111]
    ds_read_b128 v[40:43], v24 offset:17920
    ds_read_b64 v[44:45], v25 offset:18944
    s_waitcnt lgkmcnt(2)
    v_exp_f32 v84, v84
    v_exp_f32 v85, v85
    v_exp_f32 v86, v86
    v_exp_f32_e64 v87, v87
    v_cvt_pk_bf16_f32 v60, v80, v81
    v_cvt_pk_bf16_f32 v61, v82, v83
    v_rcp_f32_e64 v76, v124
    v_max3_f32 v78, abs(v112), abs(v113), abs(v114)
    v_max3_f32 v78, abs(v115), abs(v116), v78
    v_max3_f32 v78, abs(v117), abs(v118), v78
    v_max3_f32 v78, abs(v119), abs(v120), v78
    v_mfma_f32_32x32x16_bf16 v[128:143], v[232:235], v[68:71], 0
    v_exp_f32 v88, v88
    v_exp_f32 v89, v89
    v_exp_f32 v90, v90
    v_exp_f32 v91, v91
    v_cvt_pk_bf16_f32 v62, v84, v85
    v_cvt_pk_bf16_f32 v63, v86, v87
    v_max3_f32 v78, abs(v121), abs(v122), v78
    v_max_f32 v78, abs(v123), v78
    v_mul_f32_e64 v78, s72, v78
    v_max3_f32 v78, v124, v76, v78
    v_cmp_lt_f32 vcc, s73, v78
    s_cmp_lg_u64 vcc, 0
    s_cselect_b64 s[34:35], 0, 0xff
    v_mfma_f32_32x32x16_bf16 v[128:143], v[236:239], v[72:75], v[128:143]
    s_cmp_gt_i32 s77, 9
    s_cselect_b64 exec, -1, s[78:79]
    ds_read_b128 v[232:235], v26 offset:23040
    ds_read_b128 v[236:239], v26 offset:24320
    s_mov_b64 exec, -1
    s_waitcnt lgkmcnt(2)
    v_exp_f32 v92, v92
    v_exp_f32 v93, v93
    v_exp_f32 v94, v94
    v_exp_f32 v95, v95
    v_cvt_pk_bf16_f32 v64, v88, v89
    v_cvt_pk_bf16_f32 v65, v90, v91
    v_cvt_pk_bf16_f32 v66, v92, v93
    v_cvt_pk_bf16_f32 v67, v94, v95
    v_mfma_f32_32x32x16_bf16 v[80:95], v[40:43], v[48:51], 0
    v_exp_f32 v96, v96
    v_exp_f32 v97, v97
    v_exp_f32 v98, v98
    v_exp_f32 v99, v99
    v_mul_f32 v112, v76, v112
    v_mul_f32 v113, v76, v113
    v_mul_f32 v114, v76, v114
    v_mul_f32 v115, v76, v115
    v_mul_f32 v116, v76, v116
    v_mul_f32 v117, v76, v117
    v_mfma_f32_32x32x8bf16_1k v[80:95], v[44:45], v[52:53], v[80:95]
    ds_read_b128 v[40:43], v24 offset:15360
    ds_read_b64 v[44:45], v25 offset:16384
    s_waitcnt lgkmcnt(2)
    v_exp_f32 v100, v100
    v_exp_f32 v101, v101
    v_exp_f32 v102, v102
    v_exp_f32_e64 v103, v103
    v_cvt_pk_bf16_f32 v68, v96, v97
    v_cvt_pk_bf16_f32 v69, v98, v99
    v_mul_f32 v118, v76, v118
    v_mul_f32 v119, v76, v119
    v_mul_f32 v120, v76, v120
    v_mul_f32 v121, v76, v121
    v_mul_f32 v122, v76, v122
    v_mul_f32 v123, v76, v123
    v_mfma_f32_32x32x16_bf16 v[128:143], v[232:235], v[60:63], v[128:143]
    v_exp_f32 v104, v104
    v_exp_f32 v105, v105
    v_exp_f32 v106, v106
    v_exp_f32 v107, v107
    v_cvt_pk_bf16_f32 v70, v100, v101
    v_cvt_pk_bf16_f32 v71, v102, v103
    v_cvt_pk_bf16_f32 v144, v112, v113
    v_cvt_pk_bf16_f32 v145, v114, v115
    v_cvt_pk_bf16_f32 v146, v116, v117
    v_cvt_pk_bf16_f32 v147, v118, v119
    v_cvt_pk_bf16_f32 v148, v120, v121
    v_cvt_pk_bf16_f32 v149, v122, v123
    v_mfma_f32_32x32x16_bf16 v[128:143], v[236:239], v[64:67], v[128:143]
    s_waitcnt lgkmcnt(0)
    s_nop 0
    buffer_store_dwordx4 v[144:147], v28, s[36:39], s74 offen sc1
    s_mov_b32 exec_hi, 0
    s_nop 0
    buffer_store_dwordx2 v[148:149], v7, s[36:39], s74 offen offset:1024 sc1
    s_mov_b64 exec, -1
    v_exp_f32 v108, v108
    v_exp_f32 v109, v109
    v_exp_f32 v110, v110
    v_exp_f32_e64 v111, v111
    v_cvt_pk_bf16_f32 v72, v104, v105
    v_cvt_pk_bf16_f32 v73, v106, v107
    v_cvt_pk_bf16_f32 v74, v108, v109
    v_cvt_pk_bf16_f32 v75, v110, v111
    v_mfma_f32_32x32x16_bf16 v[96:111], v[40:43], v[48:51], 0
    v_exp_f32 v80, v80
    v_exp_f32 v81, v81
    v_exp_f32 v82, v82
    v_exp_f32 v83, v83
    v_mfma_f32_32x32x8bf16_1k v[96:111], v[44:45], v[52:53], v[96:111]
    ds_read_b128 v[40:43], v24 offset:12800
    ds_read_b64 v[44:45], v25 offset:13824
    v_exp_f32 v84, v84
    v_exp_f32 v85, v85
    v_exp_f32 v86, v86
    v_exp_f32 v87, v87
    v_cvt_pk_bf16_f32 v60, v80, v81
    v_cvt_pk_bf16_f32 v61, v82, v83
    v_mfma_f32_32x32x16_bf16 v[128:143], v[248:251], v[68:71], v[128:143]
    v_exp_f32 v88, v88
    v_exp_f32 v89, v89
    v_exp_f32 v90, v90
    v_exp_f32 v91, v91
    v_cvt_pk_bf16_f32 v62, v84, v85
    v_cvt_pk_bf16_f32 v63, v86, v87
    v_mfma_f32_32x32x16_bf16 v[128:143], v[252:255], v[72:75], v[128:143]
    s_waitcnt lgkmcnt(0)
    v_exp_f32 v92, v92
    v_exp_f32 v93, v93
    v_exp_f32 v94, v94
    v_exp_f32_e64 v95, v95
    v_cvt_pk_bf16_f32 v64, v88, v89
    v_cvt_pk_bf16_f32 v65, v90, v91
    v_cvt_pk_bf16_f32 v66, v92, v93
    v_cvt_pk_bf16_f32 v67, v94, v95
    v_mfma_f32_32x32x16_bf16 v[80:95], v[40:43], v[48:51], 0
    v_exp_f32 v96, v96
    v_exp_f32 v97, v97
    v_exp_f32 v98, v98
    v_exp_f32 v99, v99
    v_mfma_f32_32x32x8bf16_1k v[80:95], v[44:45], v[52:53], v[80:95]
    ds_read_b128 v[40:43], v24 offset:10240
    ds_read_b64 v[44:45], v25 offset:11264
    v_exp_f32 v100, v100
    v_exp_f32 v101, v101
    v_exp_f32 v102, v102
    v_exp_f32 v103, v103
    v_cvt_pk_bf16_f32 v68, v96, v97
    v_cvt_pk_bf16_f32 v69, v98, v99
    v_mfma_f32_32x32x16_bf16 v[128:143], v[240:243], v[60:63], v[128:143]
    v_exp_f32 v104, v104
    v_exp_f32 v105, v105
    v_exp_f32 v106, v106
    v_exp_f32 v107, v107
    v_cvt_pk_bf16_f32 v70, v100, v101
    v_cvt_pk_bf16_f32 v71, v102, v103
    v_mfma_f32_32x32x16_bf16 v[128:143], v[244:247], v[64:67], v[128:143]
    s_waitcnt lgkmcnt(0)
    v_exp_f32 v108, v108
    v_exp_f32 v109, v109
    v_exp_f32 v110, v110
    v_exp_f32_e64 v111, v111
    v_cvt_pk_bf16_f32 v72, v104, v105
    v_cvt_pk_bf16_f32 v73, v106, v107
    v_cvt_pk_bf16_f32 v74, v108, v109
    v_cvt_pk_bf16_f32 v75, v110, v111
    v_mfma_f32_32x32x16_bf16 v[96:111], v[40:43], v[48:51], 0
    v_exp_f32 v80, v80
    v_exp_f32 v81, v81
    v_exp_f32 v82, v82
    v_exp_f32 v83, v83
    v_mfma_f32_32x32x8bf16_1k v[96:111], v[44:45], v[52:53], v[96:111]
    ds_read_b128 v[40:43], v24 offset:7680
    ds_read_b64 v[44:45], v25 offset:8704
    v_exp_f32 v84, v84
    v_exp_f32 v85, v85
    v_exp_f32 v86, v86
    v_exp_f32 v87, v87
    v_cvt_pk_bf16_f32 v60, v80, v81
    v_cvt_pk_bf16_f32 v61, v82, v83
    v_mfma_f32_32x32x16_bf16 v[128:143], v[184:187], v[68:71], v[128:143]
    v_exp_f32 v88, v88
    v_exp_f32 v89, v89
    v_exp_f32 v90, v90
    v_exp_f32 v91, v91
    v_cvt_pk_bf16_f32 v62, v84, v85
    v_cvt_pk_bf16_f32 v63, v86, v87
    v_mfma_f32_32x32x16_bf16 v[128:143], v[188:191], v[72:75], v[128:143]
    s_waitcnt lgkmcnt(0)
    v_exp_f32 v92, v92
    v_exp_f32 v93, v93
    v_exp_f32 v94, v94
    v_exp_f32_e64 v95, v95
    v_cvt_pk_bf16_f32 v64, v88, v89
    v_cvt_pk_bf16_f32 v65, v90, v91
    v_cvt_pk_bf16_f32 v66, v92, v93
    v_cvt_pk_bf16_f32 v67, v94, v95
    v_mfma_f32_32x32x16_bf16 v[80:95], v[40:43], v[48:51], 0
    v_exp_f32 v96, v96
    v_exp_f32 v97, v97
    v_exp_f32 v98, v98
    v_exp_f32 v99, v99
    v_mfma_f32_32x32x8bf16_1k v[80:95], v[44:45], v[52:53], v[80:95]
    ds_read_b128 v[40:43], v24 offset:5120
    ds_read_b64 v[44:45], v25 offset:6144
    v_exp_f32 v100, v100
    v_exp_f32 v101, v101
    v_exp_f32 v102, v102
    v_exp_f32 v103, v103
    v_cvt_pk_bf16_f32 v68, v96, v97
    v_cvt_pk_bf16_f32 v69, v98, v99
    v_mfma_f32_32x32x16_bf16 v[128:143], v[176:179], v[60:63], v[128:143]
    s_waitcnt vmcnt(0)
    s_mov_b64 exec, s[34:35]
    buffer_atomic_swap v9, v8, s[36:39], s75 offen sc1
    s_mov_b64 exec, -1
    v_exp_f32 v104, v104
    v_exp_f32 v105, v105
    v_exp_f32 v106, v106
    v_exp_f32_e64 v107, v107
    v_cvt_pk_bf16_f32 v70, v100, v101
    v_cvt_pk_bf16_f32 v71, v102, v103
    v_mfma_f32_32x32x16_bf16 v[128:143], v[180:183], v[64:67], v[128:143]
    s_waitcnt lgkmcnt(0)
    v_exp_f32 v108, v108
    v_exp_f32 v109, v109
    v_exp_f32 v110, v110
    v_exp_f32_e64 v111, v111
    v_cvt_pk_bf16_f32 v72, v104, v105
    v_cvt_pk_bf16_f32 v73, v106, v107
    v_cvt_pk_bf16_f32 v74, v108, v109
    v_cvt_pk_bf16_f32 v75, v110, v111
    v_mfma_f32_32x32x16_bf16 v[96:111], v[40:43], v[48:51], v[192:207]
    v_exp_f32 v80, v80
    v_exp_f32 v81, v81
    v_exp_f32 v82, v82
    v_exp_f32 v83, v83
    v_mfma_f32_32x32x8bf16_1k v[96:111], v[44:45], v[52:53], v[96:111]
    v_exp_f32 v84, v84
    v_exp_f32 v85, v85
    v_exp_f32 v86, v86
    v_exp_f32 v87, v87
    v_cvt_pk_bf16_f32 v60, v80, v81
    v_cvt_pk_bf16_f32 v61, v82, v83
    v_mfma_f32_32x32x16_bf16 v[128:143], v[168:171], v[68:71], v[128:143]
    v_exp_f32 v88, v88
    v_exp_f32 v89, v89
    v_exp_f32 v90, v90
    v_exp_f32 v91, v91
    v_cvt_pk_bf16_f32 v62, v84, v85
    v_cvt_pk_bf16_f32 v63, v86, v87
    v_mfma_f32_32x32x16_bf16 v[128:143], v[172:175], v[72:75], v[128:143]
    v_exp_f32 v92, v92
    v_exp_f32 v93, v93
    v_exp_f32 v94, v94
    v_exp_f32 v95, v95
    v_cvt_pk_bf16_f32 v64, v88, v89
    v_cvt_pk_bf16_f32 v65, v90, v91
    v_cvt_pk_bf16_f32 v66, v92, v93
    v_cvt_pk_bf16_f32 v67, v94, v95
    v_exp_f32 v96, v96
    v_exp_f32 v97, v97
    v_exp_f32 v98, v98
    v_exp_f32 v99, v99
    v_exp_f32 v100, v100
    v_exp_f32 v101, v101
    v_exp_f32 v102, v102
    v_exp_f32 v103, v103
    v_cvt_pk_bf16_f32 v68, v96, v97
    v_cvt_pk_bf16_f32 v69, v98, v99
    v_mfma_f32_32x32x16_bf16 v[128:143], v[160:163], v[60:63], v[128:143]
    v_exp_f32 v104, v104
    v_exp_f32 v105, v105
    v_exp_f32 v106, v106
    v_exp_f32 v107, v107
    v_cvt_pk_bf16_f32 v70, v100, v101
    v_cvt_pk_bf16_f32 v71, v102, v103
    v_mfma_f32_32x32x16_bf16 v[128:143], v[164:167], v[64:67], v[128:143]
    v_exp_f32 v108, v108
    v_exp_f32 v109, v109
    v_exp_f32 v110, v110
    v_exp_f32 v111, v111
    v_cvt_pk_bf16_f32 v72, v104, v105
    v_cvt_pk_bf16_f32 v73, v106, v107
    v_cvt_pk_bf16_f32 v74, v108, v109
    v_cvt_pk_bf16_f32 v75, v110, v111
    s_nop 1
    s_nop 0
    v_mfma_f32_32x32x16_bf16 v[128:143], v[152:155], v[68:71], v[128:143]
    v_mfma_f32_32x32x16_bf16 v[128:143], v[156:159], v[72:75], v[128:143]
    s_cmp_eq_u32 s34, 0
    s_cbranch_scc1 C_fb0
C_fb0r:
    s_nop 7
    s_nop 1
    v_rcp_f32 v76, v140
    s_nop 0
    v_mul_f32 v128, v76, v128
    v_mul_f32 v129, v76, v129
    v_mul_f32 v130, v76, v130
    v_mul_f32 v131, v76, v131
    v_mul_f32 v132, v76, v132
    v_mul_f32 v133, v76, v133
    v_mul_f32 v134, v76, v134
    v_mul_f32 v135, v76, v135
    v_mul_f32 v136, v76, v136
    v_mul_f32 v137, v76, v137
    v_mul_f32 v138, v76, v138
    v_mul_f32 v139, v76, v139
    v_cvt_pk_bf16_f32 v144, v128, v129
    v_cvt_pk_bf16_f32 v145, v130, v131
    v_cvt_pk_bf16_f32 v146, v132, v133
    v_cvt_pk_bf16_f32 v147, v134, v135
    v_cvt_pk_bf16_f32 v148, v136, v137
    v_cvt_pk_bf16_f32 v149, v138, v139
    buffer_store_dwordx4 v[144:147], v28, s[36:39], s32 offen sc1
    s_mov_b32 exec_hi, 0
    buffer_store_dwordx2 v[148:149], v7, s[36:39], s32 offen offset:1024 sc1
    s_mov_b64 exec, -1
    v_max3_f32 v78, abs(v128), abs(v129), abs(v130)
    v_max3_f32 v78, abs(v131), abs(v132), v78
    v_max3_f32 v78, abs(v133), abs(v134), v78
    v_max3_f32 v78, abs(v135), abs(v136), v78
    v_max3_f32 v78, abs(v137), abs(v138), v78
    v_max_f32 v78, abs(v139), v78
    v_mul_f32 v78, s72, v78
    v_max3_f32 v78, v140, v76, v78
    v_cmp_lt_f32 vcc, s73, v78
    s_cbranch_vccnz C_fb1
C_fb1r:
    s_mov_b32 s75, s33
L_p3:
    s_lshr_b32 s77, s61, 1
    s_and_b32 s78, s61, 1
    s_lshl_b32 s72, s59, 5
    s_lshl_b32 s73, s77, 4
    s_add_u32 s73, s73, s72
    s_mul_i32 s73, s73, 1280
    s_add_u32 s74, s73, 7864320
    s_mul_i32 s72, s72, 1280
    s_lshr_b32 s73, s2, 5
    s_mul_i32 s73, s73, 160
    s_add_u32 s79, s72, s73
    v_and_b32 v10, 15, v1
    v_lshrrev_b32 v11, 4, v1
    s_lshl_b32 s72, s78, 4
    v_add_u32 v16, s72, v10
    v_lshrrev_b32 v2, 1, v11
    v_mul_u32_u24 v2, 1280, v2
    v_and_b32 v3, 1, v11
    v_lshl_add_u32 v2, v3, 9, v2
    v_lshl_add_u32 v12, v16, 4, v2
    v_mul_u32_u24 v2, 2560, v11
    v_lshl_add_u32 v17, v16, 3, v2
    v_lshrrev_b32 v2, 5, v1
    v_lshlrev_b32 v2, 4, v2
    v_bfe_u32 v3, v1, 4, 1
    v_lshl_add_u32 v2, v3, 2, v2
    v_bfe_u32 v3, v1, 2, 2
    v_add_u32 v2, v2, v3
    v_mul_u32_u24 v2, 160, v2
    v_and_b32 v3, 3, v1
    v_mul_u32_u24 v3, 40, v3
    s_mul_i32 s72, s77, 51200
    v_add3_u32 v13, v2, v3, s72
    v_mul_u32_u24 v2, 1280, v16
    v_mul_u32_u24 v3, 40, v11
    v_add_u32 v15, v2, v3
    s_lshl_b32 s76, s63, 1
    s_add_u32 s76, s76, s78
    s_mul_i32 s72, s76, 5120
    s_add_u32 s72, s72, 103424
    v_lshlrev_b32 v14, 4, v1
    v_add_u32 v14, s72, v14
    s_lshl_b32 s76, 1, s76
    s_mov_b32 s20, s74
    s_add_u32 s21, s74, 5120
    s_add_u32 s22, s74, 10240
    s_add_u32 s23, s74, 15360
    v_mov_b32 v72, 0
    v_mov_b32 v73, 0
    v_mov_b32 v74, 0
    v_mov_b32 v75, 0
    v_mov_b32 v76, 0
    v_mov_b32 v77, 0
    v_mov_b32 v78, 0
    v_mov_b32 v79, 0
    v_mov_b32 v80, 0
    v_mov_b32 v81, 0
    v_mov_b32 v82, 0
    v_mov_b32 v83, 0
    v_mov_b32 v84, 0
    v_mov_b32 v85, 0
    v_mov_b32 v86, 0
    v_mov_b32 v87, 0
    v_mov_b32 v88, 0
    v_mov_b32 v89, 0
    v_mov_b32 v90, 0
    v_mov_b32 v91, 0
    s_cmp_lg_u32 s63, 0
    s_cbranch_scc1 P3_nopost
    v_mov_b32 v3, 1
    s_waitcnt vmcnt(0)
    s_mov_b64 exec, 0xff
    buffer_atomic_swap v9, v8, s[36:39], s75 offen sc1
    s_mov_b64 exec, 1
    ds_add_u32 v31, v3 offset:0
    s_mov_b64 exec, -1
    s_setprio 0
P3_nopost:
    s_cmp_eq_u32 s63, 0
    s_cselect_b32 s75, 68, 64
    s_mov_b32 s72, 2097152
LW_9:
    ds_read_b32 v30, v31 offset:0
    s_sub_u32 s72, s72, 1
    s_waitcnt lgkmcnt(0)
    v_readfirstlane_b32 s73, v30
    s_cbranch_scc1 LWd_10
    s_cmp_ge_u32 s73, s75
    s_cbranch_scc1 LWd_10
    s_branch LW_9
LWd_10:
    s_mov_b32 s72, 262144
    s_load_dwordx16 s[4:19], s[68:69], 0 glc
    ds_read_b64_tr_b16 v[92:93], v13 offset:0
    ds_read_b64_tr_b16 v[94:95], v13 offset:1280
    ds_read_b64_tr_b16 v[96:97], v13 offset:8
    ds_read_b64_tr_b16 v[98:99], v13 offset:1288
    ds_read_b64_tr_b16 v[100:101], v13 offset:16
    ds_read_b64_tr_b16 v[102:103], v13 offset:1296
    ds_read_b64_tr_b16 v[104:105], v13 offset:24
    ds_read_b64_tr_b16 v[106:107], v13 offset:1304
    ds_read_b64_tr_b16 v[108:109], v13 offset:32
    ds_read_b64_tr_b16 v[110:111], v13 offset:1312
    ds_read_b64_tr_b16 v[112:113], v13 offset:5120
    ds_read_b64_tr_b16 v[114:115], v13 offset:6400
    ds_read_b64_tr_b16 v[116:117], v13 offset:5128
    ds_read_b64_tr_b16 v[118:119], v13 offset:6408
    ds_read_b64_tr_b16 v[120:121], v13 offset:5136
    ds_read_b64_tr_b16 v[122:123], v13 offset:6416
    ds_read_b64_tr_b16 v[124:125], v13 offset:5144
    ds_read_b64_tr_b16 v[126:127], v13 offset:6424
    ds_read_b64_tr_b16 v[128:129], v13 offset:5152
    ds_read_b64_tr_b16 v[130:131], v13 offset:6432
    ds_read_b64_tr_b16 v[132:133], v13 offset:10240
    ds_read_b64_tr_b16 v[134:135], v13 offset:11520
    ds_read_b64_tr_b16 v[136:137], v13 offset:10248
    ds_read_b64_tr_b16 v[138:139], v13 offset:11528
    ds_read_b64_tr_b16 v[140:141], v13 offset:10256
    ds_read_b64_tr_b16 v[142:143], v13 offset:11536
    ds_read_b64_tr_b16 v[144:145], v13 offset:10264
    ds_read_b64_tr_b16 v[146:147], v13 offset:11544
    ds_read_b64_tr_b16 v[148:149], v13 offset:10272
    ds_read_b64_tr_b16 v[150:151], v13 offset:11552
    ds_read_b64_tr_b16 v[152:153], v13 offset:15360
    ds_read_b64_tr_b16 v[154:155], v13 offset:16640
    ds_read_b64_tr_b16 v[156:157], v13 offset:15368
    ds_read_b64_tr_b16 v[158:159], v13 offset:16648
    ds_read_b64_tr_b16 v[160:161], v13 offset:15376
    ds_read_b64_tr_b16 v[162:163], v13 offset:16656
    ds_read_b64_tr_b16 v[164:165], v13 offset:15384
    ds_read_b64_tr_b16 v[166:167], v13 offset:16664
    ds_read_b64_tr_b16 v[168:169], v13 offset:15392
    ds_read_b64_tr_b16 v[170:171], v13 offset:16672
    ds_read_b64_tr_b16 v[172:173], v13 offset:20480
    ds_read_b64_tr_b16 v[174:175], v13 offset:21760
    ds_read_b64_tr_b16 v[176:177], v13 offset:20488
    ds_read_b64_tr_b16 v[178:179], v13 offset:21768
    ds_read_b64_tr_b16 v[180:181], v13 offset:20496
    ds_read_b64_tr_b16 v[182:183], v13 offset:21776
    ds_read_b64_tr_b16 v[184:185], v13 offset:20504
    ds_read_b64_tr_b16 v[186:187], v13 offset:21784
    ds_read_b64_tr_b16 v[188:189], v13 offset:20512
    ds_read_b64_tr_b16 v[190:191], v13 offset:21792
    s_branch P3_chk
P3_poll:
    s_load_dwordx16 s[4:19], s[68:69], 0 glc
    s_sub_u32 s72, s72, 1
    s_cbranch_scc1 P3_go
P3_chk:
    s_waitcnt lgkmcnt(0)
    s_cmp_eq_u64 s[4:5], s[64:65]
    s_cbranch_scc0 P3_poll
    s_cmp_eq_u64 s[6:7], s[64:65]
    s_cbranch_scc0 P3_poll
    s_cmp_eq_u64 s[8:9], s[64:65]
    s_cbranch_scc0 P3_poll
    s_cmp_eq_u64 s[10:11], s[64:65]
    s_cbranch_scc0 P3_poll
    s_cmp_eq_u64 s[12:13], s[64:65]
    s_cbranch_scc0 P3_poll
    s_cmp_eq_u64 s[14:15], s[64:65]
    s_cbranch_scc0 P3_poll
    s_cmp_eq_u64 s[16:17], s[64:65]
    s_cbranch_scc0 P3_poll
    s_cmp_eq_u64 s[18:19], s[64:65]
    s_cbranch_scc0 P3_poll
P3_go:
    buffer_load_dwordx4 v[32:35], v12, s[36:39], s20 offen sc1
    buffer_load_dwordx4 v[36:39], v12, s[36:39], s20 offen offset:2560 sc1
    buffer_load_dwordx4 v[40:43], v12, s[36:39], s21 offen sc1
    buffer_load_dwordx4 v[44:47], v12, s[36:39], s21 offen offset:2560 sc1
    buffer_load_dwordx4 v[48:51], v12, s[36:39], s22 offen sc1
    buffer_load_dwordx4 v[52:55], v12, s[36:39], s22 offen offset:2560 sc1
    buffer_load_dwordx4 v[56:59], v12, s[36:39], s23 offen sc1
    buffer_load_dwordx4 v[60:63], v12, s[36:39], s23 offen offset:2560 sc1
    s_waitcnt lgkmcnt(0)
.p2align 3
    s_waitcnt vmcnt(7)
    s_nop 0
    v_mfma_f32_16x16x32_bf16 v[72:75], v[92:95], v[32:35], v[72:75]
    ds_read_b64_tr_b16 v[92:93], v13 offset:25600
    ds_read_b64_tr_b16 v[94:95], v13 offset:26880
    buffer_load_dwordx2 v[64:65], v17, s[36:39], s20 offen offset:1024 sc1
    buffer_load_dwordx2 v[66:67], v17, s[36:39], s20 offen offset:2304 sc1
    v_mfma_f32_16x16x32_bf16 v[76:79], v[96:99], v[32:35], v[76:79]
    ds_read_b64_tr_b16 v[96:97], v13 offset:25608
    ds_read_b64_tr_b16 v[98:99], v13 offset:26888
    v_mfma_f32_16x16x32_bf16 v[80:83], v[100:103], v[32:35], v[80:83]
    ds_read_b64_tr_b16 v[100:101], v13 offset:25616
    ds_read_b64_tr_b16 v[102:103], v13 offset:26896
    v_mfma_f32_16x16x32_bf16 v[84:87], v[104:107], v[32:35], v[84:87]
    ds_read_b64_tr_b16 v[104:105], v13 offset:25624
    ds_read_b64_tr_b16 v[106:107], v13 offset:26904
    v_mfma_f32_16x16x32_bf16 v[88:91], v[108:111], v[32:35], v[88:91]
    ds_read_b64_tr_b16 v[108:109], v13 offset:25632
    ds_read_b64_tr_b16 v[110:111], v13 offset:26912
    s_waitcnt vmcnt(8)
    s_nop 0
    v_mfma_f32_16x16x32_bf16 v[72:75], v[112:115], v[36:39], v[72:75]
    ds_read_b64_tr_b16 v[112:113], v13 offset:30720
    ds_read_b64_tr_b16 v[114:115], v13 offset:32000
    buffer_load_dwordx2 v[68:69], v17, s[36:39], s22 offen offset:1024 sc1
    buffer_load_dwordx2 v[70:71], v17, s[36:39], s22 offen offset:2304 sc1
    v_mfma_f32_16x16x32_bf16 v[76:79], v[116:119], v[36:39], v[76:79]
    ds_read_b64_tr_b16 v[116:117], v13 offset:30728
    ds_read_b64_tr_b16 v[118:119], v13 offset:32008
    v_mfma_f32_16x16x32_bf16 v[80:83], v[120:123], v[36:39], v[80:83]
    ds_read_b64_tr_b16 v[120:121], v13 offset:30736
    ds_read_b64_tr_b16 v[122:123], v13 offset:32016
    v_mfma_f32_16x16x32_bf16 v[84:87], v[124:127], v[36:39], v[84:87]
    ds_read_b64_tr_b16 v[124:125], v13 offset:30744
    ds_read_b64_tr_b16 v[126:127], v13 offset:32024
    v_mfma_f32_16x16x32_bf16 v[88:91], v[128:131], v[36:39], v[88:91]
    ds_read_b64_tr_b16 v[128:129], v13 offset:30752
    ds_read_b64_tr_b16 v[130:131], v13 offset:32032
    s_waitcnt vmcnt(9)
    s_nop 0
    v_mfma_f32_16x16x32_bf16 v[72:75], v[132:135], v[40:43], v[72:75]
    ds_read_b64_tr_b16 v[132:133], v13 offset:35840
    ds_read_b64_tr_b16 v[134:135], v13 offset:37120
    v_mfma_f32_16x16x32_bf16 v[76:79], v[136:139], v[40:43], v[76:79]
    ds_read_b64_tr_b16 v[136:137], v13 offset:35848
    ds_read_b64_tr_b16 v[138:139], v13 offset:37128
    v_mfma_f32_16x16x32_bf16 v[80:83], v[140:143], v[40:43], v[80:83]
    ds_read_b64_tr_b16 v[140:141], v13 offset:35856
    ds_read_b64_tr_b16 v[142:143], v13 offset:37136
    v_mfma_f32_16x16x32_bf16 v[84:87], v[144:147], v[40:43], v[84:87]
    ds_read_b64_tr_b16 v[144:145], v13 offset:35864
    ds_read_b64_tr_b16 v[146:147], v13 offset:37144
    v_mfma_f32_16x16x32_bf16 v[88:91], v[148:151], v[40:43], v[88:91]
    ds_read_b64_tr_b16 v[148:149], v13 offset:35872
    ds_read_b64_tr_b16 v[150:151], v13 offset:37152
    s_waitcnt vmcnt(8)
    s_nop 0
    v_mfma_f32_16x16x32_bf16 v[72:75], v[152:155], v[44:47], v[72:75]
    ds_read_b64_tr_b16 v[152:153], v13 offset:40960
    ds_read_b64_tr_b16 v[154:155], v13 offset:42240
    v_mfma_f32_16x16x32_bf16 v[76:79], v[156:159], v[44:47], v[76:79]
    ds_read_b64_tr_b16 v[156:157], v13 offset:40968
    ds_read_b64_tr_b16 v[158:159], v13 offset:42248
    v_mfma_f32_16x16x32_bf16 v[80:83], v[160:163], v[44:47], v[80:83]
    ds_read_b64_tr_b16 v[160:161], v13 offset:40976
    ds_read_b64_tr_b16 v[162:163], v13 offset:42256
    v_mfma_f32_16x16x32_bf16 v[84:87], v[164:167], v[44:47], v[84:87]
    ds_read_b64_tr_b16 v[164:165], v13 offset:40984
    ds_read_b64_tr_b16 v[166:167], v13 offset:42264
    v_mfma_f32_16x16x32_bf16 v[88:91], v[168:171], v[44:47], v[88:91]
    ds_read_b64_tr_b16 v[168:169], v13 offset:40992
    ds_read_b64_tr_b16 v[170:171], v13 offset:42272
    s_waitcnt vmcnt(7)
    s_nop 0
    v_mfma_f32_16x16x32_bf16 v[72:75], v[172:175], v[48:51], v[72:75]
    ds_read_b64_tr_b16 v[172:173], v13 offset:46080
    ds_read_b64_tr_b16 v[174:175], v13 offset:47360
    v_mfma_f32_16x16x32_bf16 v[76:79], v[176:179], v[48:51], v[76:79]
    ds_read_b64_tr_b16 v[176:177], v13 offset:46088
    ds_read_b64_tr_b16 v[178:179], v13 offset:47368
    v_mfma_f32_16x16x32_bf16 v[80:83], v[180:183], v[48:51], v[80:83]
    ds_read_b64_tr_b16 v[180:181], v13 offset:46096
    ds_read_b64_tr_b16 v[182:183], v13 offset:47376
    v_mfma_f32_16x16x32_bf16 v[84:87], v[184:187], v[48:51], v[84:87]
    ds_read_b64_tr_b16 v[184:185], v13 offset:46104
    ds_read_b64_tr_b16 v[186:187], v13 offset:47384
    v_mfma_f32_16x16x32_bf16 v[88:91], v[188:191], v[48:51], v[88:91]
    ds_read_b64_tr_b16 v[188:189], v13 offset:46112
    ds_read_b64_tr_b16 v[190:191], v13 offset:47392
    s_waitcnt vmcnt(6) lgkmcnt(14)
    s_nop 0
    v_mfma_f32_16x16x32_bf16 v[72:75], v[92:95], v[52:55], v[72:75]
    v_mfma_f32_16x16x32_bf16 v[76:79], v[96:99], v[52:55], v[76:79]
    v_mfma_f32_16x16x32_bf16 v[80:83], v[100:103], v[52:55], v[80:83]
    v_mfma_f32_16x16x32_bf16 v[84:87], v[104:107], v[52:55], v[84:87]
    v_mfma_f32_16x16x32_bf16 v[88:91], v[108:111], v[52:55], v[88:91]
    s_waitcnt vmcnt(5) lgkmcnt(14)
    s_nop 0
    v_mfma_f32_16x16x32_bf16 v[72:75], v[112:115], v[56:59], v[72:75]
    v_mfma_f32_16x16x32_bf16 v[76:79], v[116:119], v[56:59], v[76:79]
    v_mfma_f32_16x16x32_bf16 v[80:83], v[120:123], v[56:59], v[80:83]
    v_mfma_f32_16x16x32_bf16 v[84:87], v[124:127], v[56:59], v[84:87]
    v_mfma_f32_16x16x32_bf16 v[88:91], v[128:131], v[56:59], v[88:91]
    s_waitcnt vmcnt(4) lgkmcnt(14)
    s_nop 0
    v_mfma_f32_16x16x32_bf16 v[72:75], v[132:135], v[60:63], v[72:75]
    v_mfma_f32_16x16x32_bf16 v[76:79], v[136:139], v[60:63], v[76:79]
    v_mfma_f32_16x16x32_bf16 v[80:83], v[140:143], v[60:63], v[80:83]
    v_mfma_f32_16x16x32_bf16 v[84:87], v[144:147], v[60:63], v[84:87]
    v_mfma_f32_16x16x32_bf16 v[88:91], v[148:151], v[60:63], v[88:91]
    s_waitcnt vmcnt(2) lgkmcnt(10)
    s_nop 0
    v_mfma_f32_16x16x32_bf16 v[72:75], v[152:155], v[64:67], v[72:75]
    v_mfma_f32_16x16x32_bf16 v[76:79], v[156:159], v[64:67], v[76:79]
    v_mfma_f32_16x16x32_bf16 v[80:83], v[160:163], v[64:67], v[80:83]
    v_mfma_f32_16x16x32_bf16 v[84:87], v[164:167], v[64:67], v[84:87]
    v_mfma_f32_16x16x32_bf16 v[88:91], v[168:171], v[64:67], v[88:91]
    s_waitcnt vmcnt(0) lgkmcnt(0)
    s_nop 0
    v_mfma_f32_16x16x32_bf16 v[72:75], v[172:175], v[68:71], v[72:75]
    v_mfma_f32_16x16x32_bf16 v[76:79], v[176:179], v[68:71], v[76:79]
    v_mfma_f32_16x16x32_bf16 v[80:83], v[180:183], v[68:71], v[80:83]
    v_mfma_f32_16x16x32_bf16 v[84:87], v[184:187], v[68:71], v[84:87]
    v_mfma_f32_16x16x32_bf16 v[88:91], v[188:191], v[68:71], v[88:91]
    s_cmp_eq_u32 s77, 0
    s_cbranch_scc1 P3_sum
    s_cmp_eq_u32 s63, 0
    s_cbranch_scc1 P3_wr
    s_mov_b32 s72, 2097152
LW_11:
    ds_read_b32 v30, v31 offset:0
    s_sub_u32 s72, s72, 1
    s_waitcnt lgkmcnt(0)
    v_readfirstlane_b32 s73, v30
    s_cbranch_scc1 LWd_12
    s_cmp_ge_u32 s73, 68
    s_cbranch_scc1 LWd_12
    s_sleep 1
    s_branch LW_11
LWd_12:
P3_wr:
    v_mov_b32 v3, s76
    s_nop 2
    ds_write_b128 v14, v[72:75] offset:0
    ds_write_b128 v14, v[76:79] offset:1024
    ds_write_b128 v14, v[80:83] offset:2048
    ds_write_b128 v14, v[84:87] offset:3072
    ds_write_b128 v14, v[88:91] offset:4096
    s_mov_b64 exec, 1
    ds_add_u32 v31, v3 offset:4
    s_branch L_fin
P3_sum:
    s_mov_b32 s72, 2097152
LW_13:
    ds_read_b32 v30, v31 offset:4
    s_sub_u32 s72, s72, 1
    s_waitcnt lgkmcnt(0)
    v_readfirstlane_b32 s73, v30
    s_cbranch_scc1 LWd_14
    s_and_b32 s73, s73, s76
    s_cmp_lg_u32 s73, 0
    s_cbranch_scc1 LWd_14
    s_branch LW_13
LWd_14:
    ds_read_b128 v[32:35], v14 offset:0
    ds_read_b128 v[36:39], v14 offset:1024
    ds_read_b128 v[40:43], v14 offset:2048
    ds_read_b128 v[44:47], v14 offset:3072
    ds_read_b128 v[48:51], v14 offset:4096
    s_waitcnt lgkmcnt(4)
    v_add_f32 v72, v72, v32
    v_add_f32 v73, v73, v33
    v_add_f32 v74, v74, v34
    v_add_f32 v75, v75, v35
    v_cvt_pk_bf16_f32 v56, v72, v73
    v_cvt_pk_bf16_f32 v57, v74, v75
    s_waitcnt lgkmcnt(3)
    v_add_f32 v76, v76, v36
    v_add_f32 v77, v77, v37
    v_add_f32 v78, v78, v38
    v_add_f32 v79, v79, v39
    v_cvt_pk_bf16_f32 v58, v76, v77
    v_cvt_pk_bf16_f32 v59, v78, v79
    buffer_store_dwordx4 v[56:59], v15, s[44:47], s79 offen
    s_waitcnt lgkmcnt(2)
    v_add_f32 v80, v80, v40
    v_add_f32 v81, v81, v41
    v_add_f32 v82, v82, v42
    v_add_f32 v83, v83, v43
    v_cvt_pk_bf16_f32 v60, v80, v81
    v_cvt_pk_bf16_f32 v61, v82, v83
    s_waitcnt lgkmcnt(1)
    v_add_f32 v84, v84, v44
    v_add_f32 v85, v85, v45
    v_add_f32 v86, v86, v46
    v_add_f32 v87, v87, v47
    v_cvt_pk_bf16_f32 v62, v84, v85
    v_cvt_pk_bf16_f32 v63, v86, v87
    buffer_store_dwordx4 v[60:63], v15, s[44:47], s79 offen offset:16
    s_waitcnt lgkmcnt(0)
    v_add_f32 v88, v88, v48
    v_add_f32 v89, v89, v49
    v_add_f32 v90, v90, v50
    v_add_f32 v91, v91, v51
    v_cvt_pk_bf16_f32 v64, v88, v89
    v_cvt_pk_bf16_f32 v65, v90, v91
    buffer_store_dwordx2 v[64:65], v15, s[44:47], s79 offen offset:32
L_fin:
L_end:
    s_endpgm
L_code_end:
C_fb0:
    s_nop 7
    s_nop 7
    s_sub_u32 s30, s77, 0
    s_max_i32 s30, s30, 0
    s_add_u32 s31, s30, 0
    s_mul_i32 s31, s31, 2560
    v_add_u32 v10, s31, v24
    v_add_u32 v11, s31, v25
    v_add_u32 v12, s31, v26
    v_mov_b32 v13, 4048155338
FB0_p1:
    ds_read_b128 v[40:43], v10 offset:0
    ds_read_b64 v[44:45], v11 offset:1024
    s_waitcnt lgkmcnt(0)
    s_cmp_eq_u32 s30, 0
    s_cbranch_scc1 FB_15_0
    s_cmp_eq_u32 s30, 8
    s_cbranch_scc1 FB_15_8
    v_mfma_f32_32x32x16_bf16 v[80:95], v[40:43], v[32:35], 0
    s_branch FB_15_e
FB_15_0:
    v_mfma_f32_32x32x16_bf16 v[80:95], v[40:43], v[32:35], v[192:207]
    s_branch FB_15_e
FB_15_8:
    v_mfma_f32_32x32x16_bf16 v[80:95], v[40:43], v[32:35], v[208:223]
FB_15_e:
    s_nop 7
    s_nop 7
    v_mfma_f32_32x32x8bf16_1k v[80:95], v[44:45], v[36:37], v[80:95]
    s_nop 7
    s_nop 7
    v_max3_f32 v13, v80, v81, v13
    v_max3_f32 v13, v82, v83, v13
    v_max3_f32 v13, v84, v85, v13
    v_max3_f32 v13, v86, v87, v13
    v_max3_f32 v13, v88, v89, v13
    v_max3_f32 v13, v90, v91, v13
    v_max3_f32 v13, v92, v93, v13
    v_max3_f32 v13, v94, v95, v13
    v_add_u32 v10, 2560, v10
    v_add_u32 v11, 2560, v11
    v_add_u32 v12, 2560, v12
    s_add_u32 s30, s30, 1
    s_cmp_lt_u32 s30, 9
    s_cbranch_scc1 FB0_p1
    v_mov_b32 v14, v13
    s_nop 1
    v_permlane32_swap_b32 v14, v13
    s_nop 1
    v_max_f32 v13, v14, v13
    s_sub_u32 s30, s77, 0
    s_max_i32 s30, s30, 0
    s_add_u32 s31, s30, 0
    s_mul_i32 s31, s31, 2560
    v_add_u32 v10, s31, v24
    v_add_u32 v11, s31, v25
    v_add_u32 v12, s31, v26
    v_mov_b32 v112, 0
    v_mov_b32 v113, 0
    v_mov_b32 v114, 0
    v_mov_b32 v115, 0
    v_mov_b32 v116, 0
    v_mov_b32 v117, 0
    v_mov_b32 v118, 0
    v_mov_b32 v119, 0
    v_mov_b32 v120, 0
    v_mov_b32 v121, 0
    v_mov_b32 v122, 0
    v_mov_b32 v123, 0
    v_mov_b32 v124, 0
    v_mov_b32 v125, 0
    v_mov_b32 v126, 0
    v_mov_b32 v127, 0
    v_mov_b32 v224, 0x3f803f80
    v_mov_b32 v225, 0x3f803f80
    v_mov_b32 v226, 0x3f803f80
    v_mov_b32 v227, 0x3f803f80
    v_mov_b32 v228, 0x3f803f80
    v_mov_b32 v229, 0x3f803f80
    v_mov_b32 v230, 0x3f803f80
    v_mov_b32 v231, 0x3f803f80
FB0_p2:
    ds_read_b128 v[40:43], v10 offset:0
    ds_read_b64 v[44:45], v11 offset:1024
    s_waitcnt lgkmcnt(0)
    s_cmp_eq_u32 s30, 0
    s_cbranch_scc1 FB_16_0
    s_cmp_eq_u32 s30, 8
    s_cbranch_scc1 FB_16_8
    v_mfma_f32_32x32x16_bf16 v[80:95], v[40:43], v[32:35], 0
    s_branch FB_16_e
FB_16_0:
    v_mfma_f32_32x32x16_bf16 v[80:95], v[40:43], v[32:35], v[192:207]
    s_branch FB_16_e
FB_16_8:
    v_mfma_f32_32x32x16_bf16 v[80:95], v[40:43], v[32:35], v[208:223]
FB_16_e:
    s_nop 7
    s_nop 7
    v_mfma_f32_32x32x8bf16_1k v[80:95], v[44:45], v[36:37], v[80:95]
    s_nop 7
    s_nop 7
    s_mov_b64 exec, s[78:79]
    ds_read_b128 v[224:227], v12 offset:0
    ds_read_b128 v[228:231], v12 offset:1280
    s_mov_b64 exec, -1
    v_sub_f32 v80, v80, v13
    v_sub_f32 v81, v81, v13
    v_sub_f32 v82, v82, v13
    v_sub_f32 v83, v83, v13
    v_sub_f32 v84, v84, v13
    v_sub_f32 v85, v85, v13
    v_sub_f32 v86, v86, v13
    v_sub_f32 v87, v87, v13
    v_sub_f32 v88, v88, v13
    v_sub_f32 v89, v89, v13
    v_sub_f32 v90, v90, v13
    v_sub_f32 v91, v91, v13
    v_sub_f32 v92, v92, v13
    v_sub_f32 v93, v93, v13
    v_sub_f32 v94, v94, v13
    v_sub_f32 v95, v95, v13
    v_exp_f32 v80, v80
    v_exp_f32 v81, v81
    v_exp_f32 v82, v82
    v_exp_f32 v83, v83
    v_exp_f32 v84, v84
    v_exp_f32 v85, v85
    v_exp_f32 v86, v86
    v_exp_f32 v87, v87
    v_exp_f32 v88, v88
    v_exp_f32 v89, v89
    v_exp_f32 v90, v90
    v_exp_f32 v91, v91
    v_exp_f32 v92, v92
    v_exp_f32 v93, v93
    v_exp_f32 v94, v94
    v_exp_f32 v95, v95
    s_nop 1
    v_cvt_pk_bf16_f32 v60, v80, v81
    v_cvt_pk_bf16_f32 v61, v82, v83
    v_cvt_pk_bf16_f32 v62, v84, v85
    v_cvt_pk_bf16_f32 v63, v86, v87
    v_cvt_pk_bf16_f32 v64, v88, v89
    v_cvt_pk_bf16_f32 v65, v90, v91
    v_cvt_pk_bf16_f32 v66, v92, v93
    v_cvt_pk_bf16_f32 v67, v94, v95
    s_waitcnt lgkmcnt(0)
    s_nop 1
    v_mfma_f32_32x32x16_bf16 v[112:127], v[224:227], v[60:63], v[112:127]
    v_mfma_f32_32x32x16_bf16 v[112:127], v[228:231], v[64:67], v[112:127]
    v_add_u32 v10, 2560, v10
    v_add_u32 v11, 2560, v11
    v_add_u32 v12, 2560, v12
    s_add_u32 s30, s30, 1
    s_cmp_lt_u32 s30, 9
    s_cbranch_scc1 FB0_p2
    s_nop 7
    s_nop 7
    v_rcp_f32 v76, v124
    s_nop 1
    s_waitcnt vmcnt(0)
    v_mul_f32 v112, v76, v112
    v_mul_f32 v113, v76, v113
    v_mul_f32 v114, v76, v114
    v_mul_f32 v115, v76, v115
    v_mul_f32 v116, v76, v116
    v_mul_f32 v117, v76, v117
    v_mul_f32 v118, v76, v118
    v_mul_f32 v119, v76, v119
    v_mul_f32 v120, v76, v120
    v_mul_f32 v121, v76, v121
    v_mul_f32 v122, v76, v122
    v_mul_f32 v123, v76, v123
    v_cvt_pk_bf16_f32 v144, v112, v113
    v_cvt_pk_bf16_f32 v145, v114, v115
    v_cvt_pk_bf16_f32 v146, v116, v117
    v_cvt_pk_bf16_f32 v147, v118, v119
    v_cvt_pk_bf16_f32 v148, v120, v121
    v_cvt_pk_bf16_f32 v149, v122, v123
    buffer_store_dwordx4 v[144:147], v28, s[36:39], s74 offen sc1
    s_mov_b32 exec_hi, 0
    buffer_store_dwordx2 v[148:149], v7, s[36:39], s74 offen offset:1024 sc1
    s_mov_b64 exec, -1
    s_waitcnt vmcnt(0)
    s_mov_b64 exec, 0xff
    buffer_atomic_swap v9, v8, s[36:39], s75 offen sc1
    s_mov_b64 exec, -1
    s_branch C_fb0r
C_fb1:
    s_nop 7
    s_nop 7
    s_sub_u32 s30, s77, 2
    s_max_i32 s30, s30, 0
    s_add_u32 s31, s30, 2
    s_mul_i32 s31, s31, 2560
    v_add_u32 v10, s31, v24
    v_add_u32 v11, s31, v25
    v_add_u32 v12, s31, v26
    v_mov_b32 v13, 4048155338
FB1_p1:
    ds_read_b128 v[40:43], v10 offset:0
    ds_read_b64 v[44:45], v11 offset:1024
    s_waitcnt lgkmcnt(0)
    s_cmp_eq_u32 s30, 0
    s_cbranch_scc1 FB_17_0
    s_cmp_eq_u32 s30, 8
    s_cbranch_scc1 FB_17_8
    v_mfma_f32_32x32x16_bf16 v[80:95], v[40:43], v[48:51], 0
    s_branch FB_17_e
FB_17_0:
    v_mfma_f32_32x32x16_bf16 v[80:95], v[40:43], v[48:51], v[192:207]
    s_branch FB_17_e
FB_17_8:
    v_mfma_f32_32x32x16_bf16 v[80:95], v[40:43], v[48:51], v[208:223]
FB_17_e:
    s_nop 7
    s_nop 7
    v_mfma_f32_32x32x8bf16_1k v[80:95], v[44:45], v[52:53], v[80:95]
    s_nop 7
    s_nop 7
    v_max3_f32 v13, v80, v81, v13
    v_max3_f32 v13, v82, v83, v13
    v_max3_f32 v13, v84, v85, v13
    v_max3_f32 v13, v86, v87, v13
    v_max3_f32 v13, v88, v89, v13
    v_max3_f32 v13, v90, v91, v13
    v_max3_f32 v13, v92, v93, v13
    v_max3_f32 v13, v94, v95, v13
    v_add_u32 v10, 2560, v10
    v_add_u32 v11, 2560, v11
    v_add_u32 v12, 2560, v12
    s_add_u32 s30, s30, 1
    s_cmp_lt_u32 s30, 9
    s_cbranch_scc1 FB1_p1
    v_mov_b32 v14, v13
    s_nop 1
    v_permlane32_swap_b32 v14, v13
    s_nop 1
    v_max_f32 v13, v14, v13
    s_sub_u32 s30, s77, 2
    s_max_i32 s30, s30, 0
    s_add_u32 s31, s30, 2
    s_mul_i32 s31, s31, 2560
    v_add_u32 v10, s31, v24
    v_add_u32 v11, s31, v25
    v_add_u32 v12, s31, v26
    v_mov_b32 v128, 0
    v_mov_b32 v129, 0
    v_mov_b32 v130, 0
    v_mov_b32 v131, 0
    v_mov_b32 v132, 0
    v_mov_b32 v133, 0
    v_mov_b32 v134, 0
    v_mov_b32 v135, 0
    v_mov_b32 v136, 0
    v_mov_b32 v137, 0
    v_mov_b32 v138, 0
    v_mov_b32 v139, 0
    v_mov_b32 v140, 0
    v_mov_b32 v141, 0
    v_mov_b32 v142, 0
    v_mov_b32 v143, 0
    v_mov_b32 v224, 0x3f803f80
    v_mov_b32 v225, 0x3f803f80
    v_mov_b32 v226, 0x3f803f80
    v_mov_b32 v227, 0x3f803f80
    v_mov_b32 v228, 0x3f803f80
    v_mov_b32 v229, 0x3f803f80
    v_mov_b32 v230, 0x3f803f80
    v_mov_b32 v231, 0x3f803f80
FB1_p2:
    ds_read_b128 v[40:43], v10 offset:0
    ds_read_b64 v[44:45], v11 offset:1024
    s_waitcnt lgkmcnt(0)
    s_cmp_eq_u32 s30, 0
    s_cbranch_scc1 FB_18_0
    s_cmp_eq_u32 s30, 8
    s_cbranch_scc1 FB_18_8
    v_mfma_f32_32x32x16_bf16 v[80:95], v[40:43], v[48:51], 0
    s_branch FB_18_e
FB_18_0:
    v_mfma_f32_32x32x16_bf16 v[80:95], v[40:43], v[48:51], v[192:207]
    s_branch FB_18_e
FB_18_8:
    v_mfma_f32_32x32x16_bf16 v[80:95], v[40:43], v[48:51], v[208:223]
FB_18_e:
    s_nop 7
    s_nop 7
    v_mfma_f32_32x32x8bf16_1k v[80:95], v[44:45], v[52:53], v[80:95]
    s_nop 7
    s_nop 7
    s_mov_b64 exec, s[78:79]
    ds_read_b128 v[224:227], v12 offset:0
    ds_read_b128 v[228:231], v12 offset:1280
    s_mov_b64 exec, -1
    v_sub_f32 v80, v80, v13
    v_sub_f32 v81, v81, v13
    v_sub_f32 v82, v82, v13
    v_sub_f32 v83, v83, v13
    v_sub_f32 v84, v84, v13
    v_sub_f32 v85, v85, v13
    v_sub_f32 v86, v86, v13
    v_sub_f32 v87, v87, v13
    v_sub_f32 v88, v88, v13
    v_sub_f32 v89, v89, v13
    v_sub_f32 v90, v90, v13
    v_sub_f32 v91, v91, v13
    v_sub_f32 v92, v92, v13
    v_sub_f32 v93, v93, v13
    v_sub_f32 v94, v94, v13
    v_sub_f32 v95, v95, v13
    v_exp_f32 v80, v80
    v_exp_f32 v81, v81
    v_exp_f32 v82, v82
    v_exp_f32 v83, v83
    v_exp_f32 v84, v84
    v_exp_f32 v85, v85
    v_exp_f32 v86, v86
    v_exp_f32 v87, v87
    v_exp_f32 v88, v88
    v_exp_f32 v89, v89
    v_exp_f32 v90, v90
    v_exp_f32 v91, v91
    v_exp_f32 v92, v92
    v_exp_f32 v93, v93
    v_exp_f32 v94, v94
    v_exp_f32 v95, v95
    s_nop 1
    v_cvt_pk_bf16_f32 v60, v80, v81
    v_cvt_pk_bf16_f32 v61, v82, v83
    v_cvt_pk_bf16_f32 v62, v84, v85
    v_cvt_pk_bf16_f32 v63, v86, v87
    v_cvt_pk_bf16_f32 v64, v88, v89
    v_cvt_pk_bf16_f32 v65, v90, v91
    v_cvt_pk_bf16_f32 v66, v92, v93
    v_cvt_pk_bf16_f32 v67, v94, v95
    s_waitcnt lgkmcnt(0)
    s_nop 1
    v_mfma_f32_32x32x16_bf16 v[128:143], v[224:227], v[60:63], v[128:143]
    v_mfma_f32_32x32x16_bf16 v[128:143], v[228:231], v[64:67], v[128:143]
    v_add_u32 v10, 2560, v10
    v_add_u32 v11, 2560, v11
    v_add_u32 v12, 2560, v12
    s_add_u32 s30, s30, 1
    s_cmp_lt_u32 s30, 9
    s_cbranch_scc1 FB1_p2
    s_nop 7
    s_nop 7
    v_rcp_f32 v76, v140
    s_nop 1
    s_waitcnt vmcnt(0)
    v_mul_f32 v128, v76, v128
    v_mul_f32 v129, v76, v129
    v_mul_f32 v130, v76, v130
    v_mul_f32 v131, v76, v131
    v_mul_f32 v132, v76, v132
    v_mul_f32 v133, v76, v133
    v_mul_f32 v134, v76, v134
    v_mul_f32 v135, v76, v135
    v_mul_f32 v136, v76, v136
    v_mul_f32 v137, v76, v137
    v_mul_f32 v138, v76, v138
    v_mul_f32 v139, v76, v139
    v_cvt_pk_bf16_f32 v144, v128, v129
    v_cvt_pk_bf16_f32 v145, v130, v131
    v_cvt_pk_bf16_f32 v146, v132, v133
    v_cvt_pk_bf16_f32 v147, v134, v135
    v_cvt_pk_bf16_f32 v148, v136, v137
    v_cvt_pk_bf16_f32 v149, v138, v139
    buffer_store_dwordx4 v[144:147], v28, s[36:39], s32 offen sc1
    s_mov_b32 exec_hi, 0
    buffer_store_dwordx2 v[148:149], v7, s[36:39], s32 offen offset:1024 sc1
    s_mov_b64 exec, -1
    s_branch C_fb1r
.section .rodata,"a"
.p2align 6
.amdhsa_kernel standalone__sliding_block__prompt_kernel
  .amdhsa_next_free_vgpr 256
  .amdhsa_next_free_sgpr 102
  .amdhsa_accum_offset 256
  .amdhsa_group_segment_fixed_size 0
  .amdhsa_kernarg_size 48
  .amdhsa_user_sgpr_count 2
  .amdhsa_user_sgpr_kernarg_segment_ptr 1
  .amdhsa_system_sgpr_workgroup_id_x 1
.end_amdhsa_kernel
```
